```python
import torch

def _softmax(x, axis=-1):
    return torch.softmax(x, dim=axis)
def _gelu(x):
    return torch.nn.functional.gelu(x, approximate="tanh")
def _silu(x):
    return torch.nn.functional.silu(x)
def _sigmoid(x):
    return torch.sigmoid(x)
def _layernorm(x, axis=-1, eps=1e-5):
    m = x.mean(dim=axis, keepdim=True)
    v = x.var(dim=axis, keepdim=True, unbiased=False)
    return (x - m) / torch.sqrt(v + eps)
def _scatter_add(tgt, idx, src, axis=0):
    return tgt.clone().index_add_(axis, idx, src)
def _segment_sum(src, seg, n):
    out = torch.zeros((n,) + src.shape[1:], dtype=src.dtype)
    return out.index_add_(0, seg, src)
def _pad(x, pw):
    flat = tuple(v for pair in reversed(pw) for v in pair)
    return torch.nn.functional.pad(x, flat)

kernel_name = 'standalone__gqa_softmax__near_ridge'

def setup_inputs():

    _w = (lambda a: (lambda t: t.to(torch.bfloat16) if t.is_floating_point() else t)(torch.as_tensor(a)))
    B, Hq, Hkv, Sq, Sk, D = 8, 32, 32, 288, 512, 192
    return {
        "q": _w((lambda *s: torch.randn(*s, dtype=torch.bfloat16) * 0.8)(B, Hq, Sq, D)),
        "k": _w((lambda *s: torch.randn(*s, dtype=torch.bfloat16) * 0.8)(B, Hkv, Sk, D)),
        "v": _w((lambda *s: torch.randn(*s, dtype=torch.bfloat16) * 0.05)(B, Hkv, Sk, D)),
    }

def reference(q, k, v):
    B, Hq, Sq, D = q.shape
    Hkv = k.shape[1]
    rep = Hq // Hkv
    k = (lambda x, n, axis: torch.repeat_interleave(x, n, dim=axis))(k, rep, axis=1)
    v = (lambda x, n, axis: torch.repeat_interleave(x, n, dim=axis))(v, rep, axis=1)
    scale = D ** -0.5
    scores = torch.einsum("bhqd,bhkd->bhqk", q, k) * scale
    p = _softmax(scores, axis=-1)
    return torch.einsum("bhqk,bhkd->bhqd", p, v)
```

```asm
; @launch grid=(256,1,1) block=(256,1,1) lds=163840
.amdgcn_target "amdgcn-amd-amdhsa--gfx950"
.text
.globl standalone__gqa_softmax__near_ridge_kernel
.p2align 8
.type standalone__gqa_softmax__near_ridge_kernel,@function
standalone__gqa_softmax__near_ridge_kernel:
    s_cmp_ge_u32 s2, 256
    s_cbranch_scc1 L_end
    s_load_dwordx8 s[4:11], s[0:1], 0
    s_getpc_b64 s[96:97]
L_pc:
    s_mov_b32 s99, 131072
    v_lshlrev_b32_e64 v25, 7, v0
    s_mov_b32 s98, L_peel-L_pc+0
    s_mov_b32 s100, L_pc-L_pc+0
    buffer_load_dword v160, v25, s[96:99], s100 offen
    s_mov_b32 s98, L_fallback-L_pc+2048
    s_mov_b32 s100, L_tail-L_pc+0
    buffer_load_dword v161, v25, s[96:99], s100 offen
    v_lshrrev_b32_e64 v24, 6, v0
    v_and_b32 v0, 63, v0
    v_readfirstlane_b32 s3, v24
    v_bfe_u32 v25, v0, 2, 3
    v_mul_u32_u24 v25, 384, v25
    v_lshrrev_b32_e64 v26, 5, v0
    v_lshl_add_u32 v25, v26, 6, v25
    v_and_b32_e64 v26, 3, v0
    v_bfe_u32 v27, v0, 4, 1
    v_lshlrev_b32 v27, 1, v27
    v_xor_b32 v28, v26, v27
    v_lshl_add_u32 v29, v28, 4, v25
    v_xor_b32_e64 v30, 48, v29
    s_mul_i32 s14, s2, 110592
    s_mul_i32 s15, s2, 196608
    s_mul_i32 s40, s3, 3072
    s_and_b32 s49, s3, 1
    s_mul_i32 s54, s49, 48
    s_add_u32 s55, s40, 2048
    v_xor_b32 v31, s54, v29
    v_add_u32 v11, s55, v31
    v_subrev_u32 v12, 896, v11
    v_subrev_u32 v13, 1792, v11
    s_mul_i32 s56, s3, 24576
    s_add_u32 s56, s56, 2048
    v_add_u32 v32, s56, v29
    v_add_u32 v35, s56, v30
    v_subrev_u32 v33, 896, v32
    v_subrev_u32 v36, 896, v35
    v_subrev_u32 v34, 1792, v32
    v_subrev_u32 v37, 1792, v35
    s_mov_b32 s22, 198656
    s_mov_b32 s23, 131072
    s_mov_b32 s18, 112640
    s_mov_b32 s19, 131072
    s_waitcnt lgkmcnt(0)
    s_add_u32 s20, s6, s15
    s_addc_u32 s21, s7, 0
    s_sub_u32 s20, s20, 2048
    s_subb_u32 s21, s21, 0
    s_mov_b32 m0, s40
    s_mov_b32 s54, 0
    buffer_load_dwordx4 v11, s[20:23], s54 offen offset:0 nt lds
    buffer_load_dwordx4 v12, s[20:23], s54 offen offset:1024 nt lds
    buffer_load_dwordx4 v13, s[20:23], s54 offen offset:2048 nt lds
    s_add_u32 s16, s4, s14
    s_addc_u32 s17, s5, 0
    s_sub_u32 s16, s16, 2048
    s_subb_u32 s17, s17, 0
    s_add_u32 m0, s40, 147456
    s_mov_b32 s54, 98304
    buffer_load_dwordx4 v11, s[16:19], s54 offen offset:0 nt lds
    buffer_load_dwordx4 v12, s[16:19], s54 offen offset:1024 nt lds
    buffer_load_dwordx4 v13, s[16:19], s54 offen offset:2048 nt lds
    s_add_u32 s24, s8, s15
    s_addc_u32 s25, s9, 0
    s_sub_u32 s24, s24, 2048
    s_subb_u32 s25, s25, 0
    s_mov_b32 s26, 198656
    s_mov_b32 s27, 131072
    s_add_u32 s28, s10, s14
    s_addc_u32 s29, s11, 0
    s_mov_b32 s30, 110592
    s_mov_b32 s31, 131072
    v_bfe_u32 v24, v0, 2, 3
    v_mul_u32_u24 v24, 384, v24
    v_lshrrev_b32_e64 v25, 5, v0
    v_lshl_add_u32 v24, v25, 5, v24
    v_and_b32_e64 v25, 1, v0
    v_lshl_add_u32 v24, v25, 4, v24
    v_bfe_u32 v25, v0, 1, 1
    v_bfe_u32 v26, v0, 4, 1
    v_xor_b32_e64 v25, v25, v26
    v_lshl_add_u32 v24, v25, 6, v24
    v_add_u32_e64 v14, s55, v24
    v_subrev_u32 v15, 896, v14
    v_subrev_u32 v16, 1792, v14
    s_add_u32 s41, s40, 12288
    s_add_u32 s42, s40, 24576
    s_add_u32 s43, s40, 36864
    s_mov_b32 s64, 6144
    s_mov_b32 s65, 12288
    s_mov_b32 s66, 18432
    s_lshr_b32 s50, s3, 1
    s_mov_b32 s52, 1037384597
    s_mov_b32 s53, 1037384597
    s_mov_b32 s48, 1468006400
    s_mov_b32 s47, 0
    s_mul_i32 s55, s50, 6144
    s_sub_u32 s56, 6144, s55
    v_bfe_u32 v24, v0, 2, 1
    v_bfe_u32 v25, v0, 3, 1
    v_xor_b32_e64 v24, v24, v25
    v_lshl_or_b32 v24, v24, 1, v25
    v_and_b32 v26, 7, v0
    v_lshlrev_b32 v26, 6, v26
    v_lshrrev_b32 v27, 4, v0
    v_xor_b32 v27, v27, v24
    v_lshl_add_u32 v27, v27, 4, v26
    v_mul_u32_u24 v28, 3072, v25
    v_add3_u32 v7, v27, v28, s55
    v_add3_u32 v8, v27, v28, s56
    s_mul_i32 s54, s49, 6144
    s_add_u32 s54, s54, 147456
    v_add3_u32 v40, v27, v28, s54
    v_mul_u32_u24 v28, 12288, v25
    v_add3_u32 v38, v27, v28, s40
    v_add_u32 v38, 49152, v38
    v_add_u32 v39, 49152, v38
    v_bfe_u32 v25, v0, 4, 1
    v_bfe_u32 v27, v0, 1, 1
    v_xor_b32_e64 v24, s50, v25
    v_lshl_or_b32 v27, v24, 1, v27
    v_lshlrev_b32 v27, 4, v27
    v_and_b32 v28, 1, v0
    v_lshl_or_b32 v27, v28, 3, v27
    v_bfe_u32 v26, v0, 2, 2
    v_lshl_or_b32 v27, v26, 6, v27
    v_lshl_or_b32 v27, v25, 8, v27
    v_lshrrev_b32_e64 v24, 5, v0
    v_mul_u32_u24 v28, 3072, v24
    v_add3_u32 v9, v27, v28, s55
    v_add3_u32 v10, v27, v28, s56
    v_mov_b32_e64 v1, v7
    v_mov_b32 v2, v8
    s_lshl_b32 s54, s3, 9
    s_add_u32 s54, s54, 159744
    v_lshlrev_b32 v24, 3, v0
    v_add_u32 v22, s54, v24
    v_xor_b32 v23, 1024, v22
    v_mov_b32 v17, 0
    v_mov_b32 v18, 0
    v_mov_b32 v19, 0
    v_mov_b32 v20, 0
    v_mov_b32 v21, 0
    v_mov_b32 v3, v9
    v_mov_b32 v4, v10
    v_xor_b32 v5, 32, v9
    v_xor_b32 v6, 32, v10
    s_waitcnt vmcnt(3)
    s_add_u32 m0, s40, 49152
    s_mov_b32 s54, 12288
    buffer_load_dwordx4 v32, s[16:19], s54 offen offset:0 nt lds
    buffer_load_dwordx4 v33, s[16:19], s54 offen offset:1024 nt lds
    buffer_load_dwordx4 v34, s[16:19], s54 offen offset:2048 nt lds
    s_waitcnt lgkmcnt(0)
    s_waitcnt vmcnt(3)
    s_add_u32 m0, s40, 61440
    s_mov_b32 s54, 15360
    buffer_load_dwordx4 v35, s[16:19], s54 offen offset:0 nt lds
    buffer_load_dwordx4 v36, s[16:19], s54 offen offset:1024 nt lds
    buffer_load_dwordx4 v37, s[16:19], s54 offen offset:2048 nt lds
    s_barrier
    ds_read_b128 v[232:235], v40 offset:0
    ds_read_b128 v[236:239], v40 offset:512
    ds_read_b128 v[240:243], v40 offset:1024
    ds_read_b128 v[244:247], v40 offset:1536
    ds_read_b128 v[248:251], v40 offset:2048
    ds_read_b128 v[252:255], v40 offset:2560
    ds_read_b128 v[160:163], v1 offset:0
    ds_read_b128 v[184:187], v2 offset:0
    ds_read_b128 v[164:167], v1 offset:512
    ds_read_b128 v[188:191], v2 offset:512
    ds_read_b128 v[168:171], v1 offset:1024
    ds_read_b128 v[192:195], v2 offset:1024
    ds_read_b128 v[172:175], v1 offset:1536
    ds_read_b128 v[196:199], v2 offset:1536
    ds_read_b128 v[176:179], v1 offset:2048
    s_waitcnt lgkmcnt(11)
    ds_read_b128 v[200:203], v2 offset:2048
    ds_read_b128 v[180:183], v1 offset:2560
    ds_read_b128 v[204:207], v2 offset:2560
    v_lshlrev_b32_e64 v24, 16, v232
    v_and_b32 v25, 4294901760, v232
    v_mul_f32 v24, s52, v24
    v_mul_f32 v25, s52, v25
    v_cvt_pk_bf16_f32 v232, v24, v25
    v_lshlrev_b32_e64 v26, 16, v233
    v_and_b32 v27, 4294901760, v233
    v_mul_f32 v26, s52, v26
    v_mul_f32 v27, s52, v27
    v_cvt_pk_bf16_f32 v233, v26, v27
    v_lshlrev_b32_e64 v24, 16, v234
    v_and_b32 v25, 4294901760, v234
    v_mul_f32 v24, s52, v24
    v_mul_f32 v25, s52, v25
    v_cvt_pk_bf16_f32 v234, v24, v25
    v_lshlrev_b32_e64 v26, 16, v235
    v_and_b32 v27, 4294901760, v235
    v_mul_f32 v26, s52, v26
    v_mul_f32 v27, s52, v27
    v_cvt_pk_bf16_f32 v235, v26, v27
    v_lshlrev_b32_e64 v24, 16, v236
    v_and_b32 v25, 4294901760, v236
    s_waitcnt lgkmcnt(0)
    v_mfma_f32_16x16x32_bf16 v[88:91], v[160:163], v[232:235], 0
    v_mul_f32 v24, s52, v24
    v_mul_f32_e64 v25, s52, v25
    v_mfma_f32_16x16x32_bf16 v[92:95], v[184:187], v[232:235], 0
    v_cvt_pk_bf16_f32 v236, v24, v25
    v_lshlrev_b32_e64 v26, 16, v237
    v_and_b32 v27, 4294901760, v237
    v_mul_f32 v26, s52, v26
    v_mul_f32 v27, s52, v27
    v_cvt_pk_bf16_f32 v237, v26, v27
    v_lshlrev_b32_e64 v24, 16, v238
    v_and_b32 v25, 4294901760, v238
    v_mul_f32 v24, s52, v24
    v_mul_f32 v25, s52, v25
    v_cvt_pk_bf16_f32 v238, v24, v25
    v_lshlrev_b32_e64 v26, 16, v239
    v_and_b32 v27, 4294901760, v239
    v_mul_f32 v26, s52, v26
    v_mul_f32 v27, s52, v27
    v_cvt_pk_bf16_f32 v239, v26, v27
    v_lshlrev_b32_e64 v24, 16, v240
    v_and_b32 v25, 4294901760, v240
    v_mfma_f32_16x16x32_bf16 v[88:91], v[164:167], v[236:239], v[88:91]
    v_mul_f32 v24, s52, v24
    v_mul_f32 v25, s52, v25
    v_mfma_f32_16x16x32_bf16 v[92:95], v[188:191], v[236:239], v[92:95]
    v_cvt_pk_bf16_f32 v240, v24, v25
    v_lshlrev_b32_e64 v26, 16, v241
    v_and_b32 v27, 4294901760, v241
    v_mul_f32 v26, s52, v26
    v_mul_f32 v27, s52, v27
    v_cvt_pk_bf16_f32 v241, v26, v27
    v_lshlrev_b32_e64 v24, 16, v242
    v_and_b32 v25, 4294901760, v242
    v_mul_f32 v24, s52, v24
    v_mul_f32 v25, s52, v25
    v_cvt_pk_bf16_f32 v242, v24, v25
    v_lshlrev_b32_e64 v26, 16, v243
    v_and_b32 v27, 4294901760, v243
    v_mul_f32 v26, s52, v26
    v_mul_f32 v27, s52, v27
    v_cvt_pk_bf16_f32 v243, v26, v27
    v_lshlrev_b32_e64 v24, 16, v244
    v_and_b32 v25, 4294901760, v244
    v_mfma_f32_16x16x32_bf16 v[88:91], v[168:171], v[240:243], v[88:91]
    v_mul_f32 v24, s52, v24
    v_mul_f32 v25, s52, v25
    v_mfma_f32_16x16x32_bf16 v[92:95], v[192:195], v[240:243], v[92:95]
    v_cvt_pk_bf16_f32 v244, v24, v25
    v_lshlrev_b32_e64 v26, 16, v245
    v_and_b32 v27, 4294901760, v245
    v_mul_f32 v26, s52, v26
    v_mul_f32 v27, s52, v27
    v_cvt_pk_bf16_f32 v245, v26, v27
    v_lshlrev_b32_e64 v24, 16, v246
    v_and_b32 v25, 4294901760, v246
    v_mul_f32 v24, s52, v24
    v_mul_f32 v25, s52, v25
    v_cvt_pk_bf16_f32 v246, v24, v25
    v_lshlrev_b32_e64 v26, 16, v247
    v_and_b32 v27, 4294901760, v247
    v_mul_f32 v26, s52, v26
    v_mul_f32 v27, s52, v27
    v_cvt_pk_bf16_f32 v247, v26, v27
    v_lshlrev_b32_e64 v24, 16, v248
    v_and_b32 v25, 4294901760, v248
    s_waitcnt vmcnt(3)
    s_add_u32 m0, s40, 73728
    s_mov_b32 s54, 18432
    buffer_load_dwordx4 v32, s[16:19], s54 offen offset:0 nt lds
    v_mfma_f32_16x16x32_bf16 v[88:91], v[172:175], v[244:247], v[88:91]
    v_mul_f32 v24, s52, v24
    v_mul_f32_e64 v25, s52, v25
    v_mfma_f32_16x16x32_bf16 v[92:95], v[196:199], v[244:247], v[92:95]
    v_cvt_pk_bf16_f32 v248, v24, v25
    v_lshlrev_b32_e64 v26, 16, v249
    v_and_b32 v27, 4294901760, v249
    v_mul_f32_e64 v26, s52, v26
    buffer_load_dwordx4 v33, s[16:19], s54 offen offset:1024 nt lds
    v_mul_f32_e64 v27, s52, v27
    v_cvt_pk_bf16_f32 v249, v26, v27
    v_lshlrev_b32_e64 v24, 16, v250
    v_and_b32 v25, 4294901760, v250
    v_mul_f32 v24, s52, v24
    v_mul_f32 v25, s52, v25
    v_cvt_pk_bf16_f32 v250, v24, v25
    v_lshlrev_b32_e64 v26, 16, v251
    buffer_load_dwordx4 v34, s[16:19], s54 offen offset:2048 nt lds
    v_and_b32 v27, 4294901760, v251
    v_mul_f32 v26, s52, v26
    v_mul_f32 v27, s52, v27
    v_cvt_pk_bf16_f32 v251, v26, v27
    v_lshlrev_b32_e64 v24, 16, v252
    v_and_b32 v25, 4294901760, v252
    v_mfma_f32_16x16x32_bf16 v[88:91], v[176:179], v[248:251], v[88:91]
    v_mul_f32 v24, s52, v24
    v_mul_f32 v25, s52, v25
    v_mfma_f32_16x16x32_bf16 v[92:95], v[200:203], v[248:251], v[92:95]
    v_cvt_pk_bf16_f32 v252, v24, v25
    v_lshlrev_b32_e64 v26, 16, v253
    v_and_b32 v27, 4294901760, v253
    v_mul_f32 v26, s52, v26
    v_mul_f32 v27, s52, v27
    v_cvt_pk_bf16_f32 v253, v26, v27
    v_lshlrev_b32_e64 v24, 16, v254
    v_and_b32 v25, 4294901760, v254
    v_mul_f32 v24, s52, v24
    v_mul_f32 v25, s52, v25
    v_cvt_pk_bf16_f32 v254, v24, v25
    v_lshlrev_b32_e64 v26, 16, v255
    v_and_b32 v27, 4294901760, v255
    v_mul_f32 v26, s52, v26
    v_mul_f32 v27, s52, v27
    v_cvt_pk_bf16_f32 v255, v26, v27
    v_accvgpr_write_b32 a216, v232
    v_accvgpr_write_b32 a217, v233
    v_mfma_f32_16x16x32_bf16 v[88:91], v[180:183], v[252:255], v[88:91]
    v_accvgpr_write_b32 a218, v234
    v_accvgpr_write_b32 a219, v235
    v_mfma_f32_16x16x32_bf16 v[92:95], v[204:207], v[252:255], v[92:95]
    v_accvgpr_write_b32 a220, v236
    v_accvgpr_write_b32 a221, v237
    v_accvgpr_write_b32 a222, v238
    v_accvgpr_write_b32 a223, v239
    v_accvgpr_write_b32 a224, v240
    v_max3_f32 v28, v88, v89, v90
    v_accvgpr_write_b32 a225, v241
    v_accvgpr_write_b32 a226, v242
    v_accvgpr_write_b32 a227, v243
    v_max3_f32 v28, v28, v91, v92
    v_max3_f32 v28, v28, v93, v94
    v_max_f32 v28, v28, v95
    v_mov_b32 v29, v28
    v_accvgpr_write_b32 a228, v244
    v_accvgpr_write_b32 a229, v245
    v_permlane16_swap_b32 v28, v29
    v_max_f32 v28, v28, v29
    v_mov_b32_e64 v29, v28
    v_accvgpr_write_b32 a230, v246
    v_accvgpr_write_b32 a231, v247
    v_permlane32_swap_b32 v28, v29
    v_max_f32 v28, v28, v29
    v_sub_f32 v84, 0, v28
    v_sub_f32 v85, 0, v28
    v_sub_f32 v86, 0, v28
    v_sub_f32 v87, 0, v28
    v_sub_f32 v88, v88, v28
    v_sub_f32 v89, v89, v28
    v_sub_f32 v90, v90, v28
    v_sub_f32 v91, v91, v28
    v_sub_f32 v92, v92, v28
    v_sub_f32 v93, v93, v28
    v_sub_f32 v94, v94, v28
    v_sub_f32 v95, v95, v28
    v_accvgpr_write_b32 a232, v248
    v_accvgpr_write_b32 a233, v249
    v_accvgpr_write_b32 a234, v250
    v_accvgpr_write_b32 a235, v251
    v_accvgpr_write_b32 a236, v252
    v_accvgpr_write_b32 a237, v253
    v_accvgpr_write_b32 a238, v254
    v_accvgpr_write_b32 a239, v255
    v_exp_f32 v88, v88
    v_exp_f32 v89, v89
    v_add_f32 v21, v21, v88
    v_add_f32 v21, v21, v89
    v_cvt_pk_bf16_f32 v88, v88, v89
    v_exp_f32 v90, v90
    v_exp_f32 v91, v91
    v_add_f32 v21, v21, v90
    v_add_f32 v21, v21, v91
    v_cvt_pk_bf16_f32 v89, v90, v91
    v_exp_f32_e64 v92, v92
    v_exp_f32 v93, v93
    s_nop 0
    v_cvt_pk_bf16_f32 v90, v92, v93
    v_exp_f32_e64 v94, v94
    v_exp_f32 v95, v95
    s_nop 0
    v_cvt_pk_bf16_f32 v91, v94, v95
    s_waitcnt vmcnt(3)
    ds_read_b128 v[232:235], v38 offset:0
    ds_read_b128 v[236:239], v38 offset:512
    ds_read_b128 v[240:243], v38 offset:1024
    ds_read_b128 v[244:247], v38 offset:1536
    ds_read_b128 v[248:251], v38 offset:2048
    ds_read_b128 v[252:255], v38 offset:2560
    s_waitcnt lgkmcnt(5)
    v_lshlrev_b32_e64 v24, 16, v232
    v_and_b32 v25, 4294901760, v232
    s_add_u32 m0, s40, 86016
    s_mov_b32 s54, 21504
    buffer_load_dwordx4 v35, s[16:19], s54 offen offset:0 nt lds
    v_mul_f32 v24, s52, v24
    v_mul_f32 v25, s52, v25
    v_cvt_pk_bf16_f32 v232, v24, v25
    v_lshlrev_b32_e64 v26, 16, v233
    v_and_b32 v27, 4294901760, v233
    v_mul_f32 v26, s52, v26
    v_mul_f32 v27, s52, v27
    v_cvt_pk_bf16_f32 v233, v26, v27
    buffer_load_dwordx4 v36, s[16:19], s54 offen offset:1024 nt lds
    v_lshlrev_b32_e64 v24, 16, v234
    v_and_b32 v25, 4294901760, v234
    v_mul_f32 v24, s52, v24
    v_mul_f32 v25, s52, v25
    v_cvt_pk_bf16_f32 v234, v24, v25
    v_lshlrev_b32_e64 v26, 16, v235
    v_and_b32 v27, 4294901760, v235
    v_mul_f32_e64 v26, s52, v26
    buffer_load_dwordx4 v37, s[16:19], s54 offen offset:2048 nt lds
    v_mul_f32_e64 v27, s52, v27
    v_cvt_pk_bf16_f32 v235, v26, v27
    s_waitcnt lgkmcnt(0)
    v_lshlrev_b32 v24, 16, v236
    v_and_b32 v25, 4294901760, v236
    v_mfma_f32_16x16x32_bf16 v[112:115], v[160:163], v[232:235], 0
    v_mul_f32 v24, s52, v24
    v_mul_f32 v25, s52, v25
    v_mfma_f32_16x16x32_bf16 v[116:119], v[184:187], v[232:235], 0
    v_cvt_pk_bf16_f32 v236, v24, v25
    v_lshlrev_b32_e64 v26, 16, v237
    v_and_b32 v27, 4294901760, v237
    v_mul_f32 v26, s52, v26
    v_mul_f32 v27, s52, v27
    v_cvt_pk_bf16_f32 v237, v26, v27
    v_lshlrev_b32_e64 v24, 16, v238
    v_and_b32 v25, 4294901760, v238
    v_mul_f32 v24, s52, v24
    v_mul_f32 v25, s52, v25
    v_cvt_pk_bf16_f32 v238, v24, v25
    v_lshlrev_b32_e64 v26, 16, v239
    v_and_b32 v27, 4294901760, v239
    v_mul_f32 v26, s52, v26
    v_mul_f32 v27, s52, v27
    v_cvt_pk_bf16_f32 v239, v26, v27
    v_lshlrev_b32_e64 v24, 16, v240
    v_and_b32 v25, 4294901760, v240
    v_mfma_f32_16x16x32_bf16 v[112:115], v[164:167], v[236:239], v[112:115]
    v_mul_f32 v24, s52, v24
    v_mul_f32 v25, s52, v25
    v_mfma_f32_16x16x32_bf16 v[116:119], v[188:191], v[236:239], v[116:119]
    v_cvt_pk_bf16_f32 v240, v24, v25
    v_lshlrev_b32_e64 v26, 16, v241
    v_and_b32 v27, 4294901760, v241
    v_mul_f32 v26, s52, v26
    v_mul_f32 v27, s52, v27
    v_cvt_pk_bf16_f32 v241, v26, v27
    v_lshlrev_b32_e64 v24, 16, v242
    v_and_b32 v25, 4294901760, v242
    v_mul_f32 v24, s52, v24
    v_mul_f32 v25, s52, v25
    v_cvt_pk_bf16_f32 v242, v24, v25
    v_lshlrev_b32_e64 v26, 16, v243
    v_and_b32 v27, 4294901760, v243
    v_mul_f32 v26, s52, v26
    v_mul_f32 v27, s52, v27
    v_cvt_pk_bf16_f32 v243, v26, v27
    v_lshlrev_b32_e64 v24, 16, v244
    v_and_b32 v25, 4294901760, v244
    v_mfma_f32_16x16x32_bf16 v[112:115], v[168:171], v[240:243], v[112:115]
    v_mul_f32 v24, s52, v24
    v_mul_f32 v25, s52, v25
    v_mfma_f32_16x16x32_bf16 v[116:119], v[192:195], v[240:243], v[116:119]
    v_cvt_pk_bf16_f32 v244, v24, v25
    v_lshlrev_b32_e64 v26, 16, v245
    v_and_b32 v27, 4294901760, v245
    v_mul_f32 v26, s52, v26
    v_mul_f32 v27, s52, v27
    v_cvt_pk_bf16_f32 v245, v26, v27
    v_lshlrev_b32_e64 v24, 16, v246
    v_and_b32 v25, 4294901760, v246
    v_mul_f32 v24, s52, v24
    v_mul_f32 v25, s52, v25
    v_cvt_pk_bf16_f32 v246, v24, v25
    v_lshlrev_b32_e64 v26, 16, v247
    v_and_b32 v27, 4294901760, v247
    v_mul_f32 v26, s52, v26
    v_mul_f32 v27, s52, v27
    v_cvt_pk_bf16_f32 v247, v26, v27
    v_lshlrev_b32_e64 v24, 16, v248
    v_and_b32 v25, 4294901760, v248
    v_mfma_f32_16x16x32_bf16 v[112:115], v[172:175], v[244:247], v[112:115]
    v_mul_f32 v24, s52, v24
    v_mul_f32 v25, s52, v25
    v_mfma_f32_16x16x32_bf16 v[116:119], v[196:199], v[244:247], v[116:119]
    v_cvt_pk_bf16_f32 v248, v24, v25
    s_waitcnt vmcnt(3)
    s_add_u32 m0, s40, 24576
    s_mov_b32 s54, 12288
    buffer_load_dwordx4 v11, s[20:23], s54 offen offset:0 nt lds
    v_lshlrev_b32 v26, 16, v249
    v_and_b32 v27, 4294901760, v249
    v_mul_f32 v26, s52, v26
    v_mul_f32 v27, s52, v27
    v_cvt_pk_bf16_f32 v249, v26, v27
    v_lshlrev_b32_e64 v24, 16, v250
    v_and_b32 v25, 4294901760, v250
    v_mul_f32_e64 v24, s52, v24
    buffer_load_dwordx4 v12, s[20:23], s54 offen offset:1024 nt lds
    v_mul_f32_e64 v25, s52, v25
    v_cvt_pk_bf16_f32 v250, v24, v25
    v_lshlrev_b32_e64 v26, 16, v251
    v_and_b32 v27, 4294901760, v251
    v_mul_f32 v26, s52, v26
    v_mul_f32 v27, s52, v27
    v_cvt_pk_bf16_f32 v251, v26, v27
    v_lshlrev_b32_e64 v24, 16, v252
    buffer_load_dwordx4 v13, s[20:23], s54 offen offset:2048 nt lds
    v_and_b32 v25, 4294901760, v252
    v_mfma_f32_16x16x32_bf16 v[112:115], v[176:179], v[248:251], v[112:115]
    v_mul_f32 v24, s52, v24
    v_mul_f32 v25, s52, v25
    v_mfma_f32_16x16x32_bf16 v[116:119], v[200:203], v[248:251], v[116:119]
    v_cvt_pk_bf16_f32 v252, v24, v25
    v_lshlrev_b32_e64 v26, 16, v253
    v_and_b32 v27, 4294901760, v253
    v_mul_f32 v26, s52, v26
    v_mul_f32 v27, s52, v27
    v_cvt_pk_bf16_f32 v253, v26, v27
    v_lshlrev_b32_e64 v24, 16, v254
    v_and_b32 v25, 4294901760, v254
    v_mul_f32 v24, s52, v24
    v_mul_f32 v25, s52, v25
    v_cvt_pk_bf16_f32 v254, v24, v25
    v_lshlrev_b32_e64 v26, 16, v255
    v_and_b32 v27, 4294901760, v255
    v_mul_f32 v26, s52, v26
    v_mul_f32 v27, s52, v27
    v_cvt_pk_bf16_f32 v255, v26, v27
    v_accvgpr_write_b32 a168, v232
    v_accvgpr_write_b32 a169, v233
    v_mfma_f32_16x16x32_bf16 v[112:115], v[180:183], v[252:255], v[112:115]
    v_accvgpr_write_b32 a170, v234
    v_accvgpr_write_b32 a171, v235
    v_mfma_f32_16x16x32_bf16 v[116:119], v[204:207], v[252:255], v[116:119]
    v_accvgpr_write_b32 a172, v236
    v_accvgpr_write_b32 a173, v237
    v_accvgpr_write_b32 a174, v238
    v_accvgpr_write_b32 a175, v239
    v_accvgpr_write_b32 a176, v240
    v_max3_f32 v28, v112, v113, v114
    v_accvgpr_write_b32 a177, v241
    v_accvgpr_write_b32 a178, v242
    v_accvgpr_write_b32 a179, v243
    v_max3_f32 v28, v28, v115, v116
    v_max3_f32 v28, v28, v117, v118
    v_max_f32 v28, v28, v119
    v_mov_b32 v29, v28
    v_accvgpr_write_b32 a180, v244
    v_accvgpr_write_b32 a181, v245
    v_permlane16_swap_b32 v28, v29
    v_max_f32 v28, v28, v29
    v_mov_b32_e64 v29, v28
    v_accvgpr_write_b32 a182, v246
    v_accvgpr_write_b32 a183, v247
    v_permlane32_swap_b32 v28, v29
    v_max_f32 v28, v28, v29
    v_sub_f32 v76, 0, v28
    v_sub_f32 v77, 0, v28
    v_sub_f32 v78, 0, v28
    v_sub_f32 v79, 0, v28
    v_sub_f32 v112, v112, v28
    v_sub_f32 v113, v113, v28
    v_sub_f32 v114, v114, v28
    v_sub_f32 v115, v115, v28
    v_sub_f32 v116, v116, v28
    v_sub_f32 v117, v117, v28
    v_sub_f32 v118, v118, v28
    v_sub_f32 v119, v119, v28
    v_accvgpr_write_b32 a184, v248
    v_accvgpr_write_b32 a185, v249
    v_accvgpr_write_b32 a186, v250
    v_accvgpr_write_b32 a187, v251
    v_accvgpr_write_b32 a188, v252
    v_accvgpr_write_b32 a189, v253
    v_accvgpr_write_b32 a190, v254
    v_accvgpr_write_b32 a191, v255
    v_exp_f32 v112, v112
    v_exp_f32 v113, v113
    v_add_f32 v19, v19, v112
    v_add_f32 v19, v19, v113
    v_cvt_pk_bf16_f32 v112, v112, v113
    v_exp_f32 v114, v114
    v_exp_f32 v115, v115
    v_add_f32 v19, v19, v114
    v_add_f32 v19, v19, v115
    v_cvt_pk_bf16_f32 v113, v114, v115
    v_exp_f32 v116, v116
    v_exp_f32 v117, v117
    v_add_f32 v19, v19, v116
    v_add_f32 v19, v19, v117
    v_cvt_pk_bf16_f32 v114, v116, v117
    v_exp_f32 v118, v118
    v_exp_f32 v119, v119
    v_add_f32 v19, v19, v118
    v_add_f32 v19, v19, v119
    v_cvt_pk_bf16_f32 v115, v118, v119
    s_waitcnt vmcnt(3)
    ds_read_b128 v[232:235], v38 offset:24576
    ds_read_b128 v[236:239], v38 offset:25088
    ds_read_b128 v[240:243], v38 offset:25600
    ds_read_b128 v[244:247], v38 offset:26112
    ds_read_b128 v[248:251], v38 offset:26624
    ds_read_b128 v[252:255], v38 offset:27136
    s_waitcnt lgkmcnt(5)
    v_lshlrev_b32_e64 v24, 16, v232
    v_and_b32 v25, 4294901760, v232
    s_add_u32 m0, s40, 12288
    s_mov_b32 s54, 0
    buffer_load_dwordx4 v14, s[24:27], s54 offen offset:0 nt lds
    v_mul_f32 v24, s52, v24
    v_mul_f32_e64 v25, s52, v25
    v_cvt_pk_bf16_f32 v232, v24, v25
    v_lshlrev_b32_e64 v26, 16, v233
    v_and_b32 v27, 4294901760, v233
    v_mul_f32 v26, s52, v26
    v_mul_f32 v27, s52, v27
    v_cvt_pk_bf16_f32 v233, v26, v27
    buffer_load_dwordx4 v15, s[24:27], s54 offen offset:1024 nt lds
    v_lshlrev_b32_e64 v24, 16, v234
    v_and_b32 v25, 4294901760, v234
    v_mul_f32 v24, s52, v24
    v_mul_f32 v25, s52, v25
    v_cvt_pk_bf16_f32 v234, v24, v25
    v_lshlrev_b32_e64 v26, 16, v235
    v_and_b32 v27, 4294901760, v235
    v_mul_f32_e64 v26, s52, v26
    buffer_load_dwordx4 v16, s[24:27], s54 offen offset:2048 nt lds
    v_mul_f32_e64 v27, s52, v27
    v_cvt_pk_bf16_f32 v235, v26, v27
    s_waitcnt lgkmcnt(0)
    v_lshlrev_b32 v24, 16, v236
    v_and_b32 v25, 4294901760, v236
    v_mfma_f32_16x16x32_bf16 v[120:123], v[160:163], v[232:235], 0
    v_mul_f32 v24, s52, v24
    v_mul_f32 v25, s52, v25
    v_mfma_f32_16x16x32_bf16 v[124:127], v[184:187], v[232:235], 0
    v_cvt_pk_bf16_f32 v236, v24, v25
    v_lshlrev_b32_e64 v26, 16, v237
    v_and_b32 v27, 4294901760, v237
    v_mul_f32 v26, s52, v26
    v_mul_f32 v27, s52, v27
    v_cvt_pk_bf16_f32 v237, v26, v27
    v_lshlrev_b32_e64 v24, 16, v238
    v_and_b32 v25, 4294901760, v238
    v_mul_f32 v24, s52, v24
    v_mul_f32 v25, s52, v25
    v_cvt_pk_bf16_f32 v238, v24, v25
    v_lshlrev_b32_e64 v26, 16, v239
    v_and_b32 v27, 4294901760, v239
    v_mul_f32 v26, s52, v26
    v_mul_f32 v27, s52, v27
    v_cvt_pk_bf16_f32 v239, v26, v27
    v_lshlrev_b32_e64 v24, 16, v240
    v_and_b32 v25, 4294901760, v240
    v_mfma_f32_16x16x32_bf16 v[120:123], v[164:167], v[236:239], v[120:123]
    v_mul_f32 v24, s52, v24
    v_mul_f32 v25, s52, v25
    v_mfma_f32_16x16x32_bf16 v[124:127], v[188:191], v[236:239], v[124:127]
    v_cvt_pk_bf16_f32 v240, v24, v25
    v_lshlrev_b32_e64 v26, 16, v241
    v_and_b32 v27, 4294901760, v241
    v_mul_f32 v26, s52, v26
    v_mul_f32 v27, s52, v27
    v_cvt_pk_bf16_f32 v241, v26, v27
    v_lshlrev_b32_e64 v24, 16, v242
    v_and_b32 v25, 4294901760, v242
    v_mul_f32 v24, s52, v24
    v_mul_f32 v25, s52, v25
    v_cvt_pk_bf16_f32 v242, v24, v25
    v_lshlrev_b32_e64 v26, 16, v243
    v_and_b32 v27, 4294901760, v243
    v_mul_f32 v26, s52, v26
    v_mul_f32 v27, s52, v27
    v_cvt_pk_bf16_f32 v243, v26, v27
    v_lshlrev_b32_e64 v24, 16, v244
    v_and_b32 v25, 4294901760, v244
    v_mfma_f32_16x16x32_bf16 v[120:123], v[168:171], v[240:243], v[120:123]
    v_mul_f32 v24, s52, v24
    v_mul_f32 v25, s52, v25
    v_mfma_f32_16x16x32_bf16 v[124:127], v[192:195], v[240:243], v[124:127]
    v_cvt_pk_bf16_f32 v244, v24, v25
    v_lshlrev_b32_e64 v26, 16, v245
    v_and_b32 v27, 4294901760, v245
    v_mul_f32 v26, s52, v26
    v_mul_f32 v27, s52, v27
    v_cvt_pk_bf16_f32 v245, v26, v27
    v_lshlrev_b32_e64 v24, 16, v246
    v_and_b32 v25, 4294901760, v246
    v_mul_f32 v24, s52, v24
    v_mul_f32 v25, s52, v25
    v_cvt_pk_bf16_f32 v246, v24, v25
    v_lshlrev_b32_e64 v26, 16, v247
    v_and_b32 v27, 4294901760, v247
    v_mul_f32 v26, s52, v26
    v_mul_f32 v27, s52, v27
    v_cvt_pk_bf16_f32 v247, v26, v27
    v_lshlrev_b32_e64 v24, 16, v248
    v_and_b32 v25, 4294901760, v248
    v_mfma_f32_16x16x32_bf16 v[120:123], v[172:175], v[244:247], v[120:123]
    v_mul_f32 v24, s52, v24
    v_mul_f32 v25, s52, v25
    v_mfma_f32_16x16x32_bf16 v[124:127], v[196:199], v[244:247], v[124:127]
    v_cvt_pk_bf16_f32 v248, v24, v25
    s_waitcnt vmcnt(3)
    s_add_u32 m0, s40, 98304
    s_mov_b32 s54, 0
    buffer_load_dwordx4 v32, s[16:19], s54 offen offset:0 nt lds
    v_lshlrev_b32_e64 v26, 16, v249
    v_and_b32 v27, 4294901760, v249
    v_mul_f32 v26, s52, v26
    v_mul_f32 v27, s52, v27
    v_cvt_pk_bf16_f32 v249, v26, v27
    v_lshlrev_b32_e64 v24, 16, v250
    v_and_b32 v25, 4294901760, v250
    v_mul_f32_e64 v24, s52, v24
    buffer_load_dwordx4 v33, s[16:19], s54 offen offset:1024 nt lds
    v_mul_f32_e64 v25, s52, v25
    v_cvt_pk_bf16_f32 v250, v24, v25
    v_lshlrev_b32_e64 v26, 16, v251
    v_and_b32 v27, 4294901760, v251
    v_mul_f32 v26, s52, v26
    v_mul_f32 v27, s52, v27
    v_cvt_pk_bf16_f32 v251, v26, v27
    v_lshlrev_b32_e64 v24, 16, v252
    buffer_load_dwordx4 v34, s[16:19], s54 offen offset:2048 nt lds
    v_and_b32 v25, 4294901760, v252
    v_mfma_f32_16x16x32_bf16 v[120:123], v[176:179], v[248:251], v[120:123]
    v_mul_f32 v24, s52, v24
    v_mul_f32 v25, s52, v25
    v_mfma_f32_16x16x32_bf16 v[124:127], v[200:203], v[248:251], v[124:127]
    v_cvt_pk_bf16_f32 v252, v24, v25
    v_lshlrev_b32_e64 v26, 16, v253
    v_and_b32 v27, 4294901760, v253
    v_mul_f32 v26, s52, v26
    v_mul_f32 v27, s52, v27
    v_cvt_pk_bf16_f32 v253, v26, v27
    v_lshlrev_b32_e64 v24, 16, v254
    v_and_b32 v25, 4294901760, v254
    v_mul_f32 v24, s52, v24
    v_mul_f32 v25, s52, v25
    v_cvt_pk_bf16_f32 v254, v24, v25
    v_lshlrev_b32_e64 v26, 16, v255
    v_and_b32 v27, 4294901760, v255
    v_mul_f32 v26, s52, v26
    v_mul_f32 v27, s52, v27
    v_cvt_pk_bf16_f32 v255, v26, v27
    v_accvgpr_write_b32 a192, v232
    v_accvgpr_write_b32 a193, v233
    v_mfma_f32_16x16x32_bf16 v[120:123], v[180:183], v[252:255], v[120:123]
    v_accvgpr_write_b32 a194, v234
    v_accvgpr_write_b32 a195, v235
    v_mfma_f32_16x16x32_bf16 v[124:127], v[204:207], v[252:255], v[124:127]
    v_accvgpr_write_b32 a196, v236
    v_accvgpr_write_b32 a197, v237
    v_accvgpr_write_b32 a198, v238
    v_accvgpr_write_b32 a199, v239
    v_accvgpr_write_b32 a200, v240
    v_max3_f32 v28, v120, v121, v122
    v_accvgpr_write_b32 a201, v241
    v_accvgpr_write_b32 a202, v242
    v_accvgpr_write_b32 a203, v243
    v_max3_f32 v28, v28, v123, v124
    v_max3_f32 v28, v28, v125, v126
    v_max_f32 v28, v28, v127
    v_mov_b32 v29, v28
    v_accvgpr_write_b32 a204, v244
    v_accvgpr_write_b32 a205, v245
    v_permlane16_swap_b32 v28, v29
    v_max_f32 v28, v28, v29
    v_mov_b32_e64 v29, v28
    v_accvgpr_write_b32 a206, v246
    v_accvgpr_write_b32 a207, v247
    v_permlane32_swap_b32 v28, v29
    v_max_f32 v28, v28, v29
    v_sub_f32 v80, 0, v28
    v_sub_f32 v81, 0, v28
    v_sub_f32 v82, 0, v28
    v_sub_f32 v83, 0, v28
    v_sub_f32 v120, v120, v28
    v_sub_f32 v121, v121, v28
    v_sub_f32 v122, v122, v28
    v_sub_f32 v123, v123, v28
    v_sub_f32 v124, v124, v28
    v_sub_f32 v125, v125, v28
    v_sub_f32 v126, v126, v28
    v_sub_f32 v127, v127, v28
    v_accvgpr_write_b32 a208, v248
    v_accvgpr_write_b32 a209, v249
    v_accvgpr_write_b32 a210, v250
    v_accvgpr_write_b32 a211, v251
    v_accvgpr_write_b32 a212, v252
    v_accvgpr_write_b32 a213, v253
    v_accvgpr_write_b32 a214, v254
    v_accvgpr_write_b32 a215, v255
    v_exp_f32 v120, v120
    v_exp_f32 v121, v121
    v_add_f32 v20, v20, v120
    v_add_f32 v20, v20, v121
    v_cvt_pk_bf16_f32 v120, v120, v121
    v_exp_f32 v122, v122
    v_exp_f32 v123, v123
    v_add_f32 v20, v20, v122
    v_add_f32 v20, v20, v123
    v_cvt_pk_bf16_f32 v121, v122, v123
    v_exp_f32 v124, v124
    v_exp_f32 v125, v125
    v_add_f32 v20, v20, v124
    v_add_f32 v20, v20, v125
    v_cvt_pk_bf16_f32 v122, v124, v125
    v_exp_f32 v126, v126
    v_exp_f32 v127, v127
    v_add_f32 v20, v20, v126
    v_add_f32 v20, v20, v127
    v_cvt_pk_bf16_f32 v123, v126, v127
    s_waitcnt lgkmcnt(0)
    s_waitcnt vmcnt(3)
    s_add_u32 m0, s40, 110592
    s_mov_b32 s54, 3072
    buffer_load_dwordx4 v35, s[16:19], s54 offen offset:0 nt lds
    buffer_load_dwordx4 v36, s[16:19], s54 offen offset:1024 nt lds
    buffer_load_dwordx4 v37, s[16:19], s54 offen offset:2048 nt lds
    s_barrier
    ds_read_b128 v[44:47], v1 offset:24576
    ds_read_b128 v[48:51], v1 offset:25088
    ds_read_b128 v[52:55], v1 offset:25600
    ds_read_b128 v[56:59], v1 offset:26112
    ds_read_b128 v[60:63], v1 offset:26624
    ds_read_b128 v[64:67], v1 offset:27136
    ds_read_b128 a[240:243], v2 offset:24576
    ds_read_b128 a[244:247], v2 offset:25088
    ds_read_b128 a[248:251], v2 offset:25600
    ds_read_b128 a[252:255], v2 offset:26112
    s_waitcnt lgkmcnt(9)
    v_mfma_f32_16x16x32_bf16 v[92:95], v[44:47], a[216:219], v[84:87]
    v_mfma_f32_16x16x32_bf16 v[144:147], v[44:47], a[168:171], v[76:79]
    v_mfma_f32_16x16x32_bf16 v[152:155], v[44:47], a[192:195], v[80:83]
    ds_read_b128 v[44:47], v2 offset:26624
    s_waitcnt lgkmcnt(9)
    v_mfma_f32_16x16x32_bf16 v[92:95], v[48:51], a[220:223], v[92:95]
    v_mfma_f32_16x16x32_bf16 v[144:147], v[48:51], a[172:175], v[144:147]
    v_mfma_f32_16x16x32_bf16 v[152:155], v[48:51], a[196:199], v[152:155]
    ds_read_b128 v[48:51], v2 offset:27136
    s_waitcnt lgkmcnt(9)
    v_mfma_f32_16x16x32_bf16 v[92:95], v[52:55], a[224:227], v[92:95]
    v_mfma_f32_16x16x32_bf16 v[144:147], v[52:55], a[176:179], v[144:147]
    v_mfma_f32_16x16x32_bf16 v[152:155], v[52:55], a[200:203], v[152:155]
    ds_read_b64_tr_b16 v[52:53], v3 offset:12288
    ds_read_b64_tr_b16 v[54:55], v4 offset:12288
    s_waitcnt lgkmcnt(7)
    v_mfma_f32_16x16x32_bf16 v[92:95], v[56:59], a[228:231], v[92:95]
    v_mfma_f32_16x16x32_bf16 v[144:147], v[56:59], a[180:183], v[144:147]
    v_mfma_f32_16x16x32_bf16 v[152:155], v[56:59], a[204:207], v[152:155]
    ds_read_b64_tr_b16 v[56:57], v5 offset:12288
    ds_read_b64_tr_b16 v[58:59], v6 offset:12288
    v_mfma_f32_16x16x32_bf16 v[92:95], v[60:63], a[232:235], v[92:95]
    v_mfma_f32_16x16x32_bf16 v[144:147], v[60:63], a[184:187], v[144:147]
    v_mfma_f32_16x16x32_bf16 v[152:155], v[60:63], a[208:211], v[152:155]
    ds_read_b64_tr_b16 v[60:61], v3 offset:12800
    ds_read_b64_tr_b16 v[62:63], v4 offset:12800
    v_mfma_f32_16x16x32_bf16 v[92:95], v[64:67], a[236:239], v[92:95]
    v_mfma_f32_16x16x32_bf16 v[144:147], v[64:67], a[188:191], v[144:147]
    v_mfma_f32_16x16x32_bf16 v[152:155], v[64:67], a[212:215], v[152:155]
    ds_read_b64_tr_b16 v[64:65], v5 offset:12800
    ds_read_b64_tr_b16 v[66:67], v6 offset:12800
    v_mfma_f32_16x16x32_bf16 v[148:151], a[240:243], a[168:171], v[76:79]
    s_nop 2
    v_exp_f32_e64 v92, v92
    v_mfma_f32_16x16x32_bf16 v[156:159], a[240:243], a[192:195], v[80:83]
    ds_read_b64_tr_b16 a[240:241], v3 offset:13312
    ds_read_b64_tr_b16 a[242:243], v4 offset:13312
    s_waitcnt lgkmcnt(8)
    v_mfma_f32_16x16x32_bf16 v[148:151], a[244:247], a[172:175], v[148:151]
    v_exp_f32 v93, v93
    v_mfma_f32_16x16x32_bf16 v[156:159], a[244:247], a[196:199], v[156:159]
    ds_read_b64_tr_b16 a[244:245], v5 offset:13312
    ds_read_b64_tr_b16 a[246:247], v6 offset:13312
    v_mfma_f32_16x16x32_bf16 v[148:151], a[248:251], a[176:179], v[148:151]
    v_add_f32 v21, v21, v92
    v_add_f32 v21, v21, v93
    v_mfma_f32_16x16x32_bf16 v[156:159], a[248:251], a[200:203], v[156:159]
    ds_read_b64_tr_b16 a[248:249], v3 offset:13824
    ds_read_b64_tr_b16 a[250:251], v4 offset:13824
    v_mfma_f32_16x16x32_bf16 v[148:151], a[252:255], a[180:183], v[148:151]
    v_cvt_pk_bf16_f32 v92, v92, v93
    v_exp_f32_e64 v94, v94
    v_mfma_f32_16x16x32_bf16 v[156:159], a[252:255], a[204:207], v[156:159]
    ds_read_b64_tr_b16 a[252:253], v5 offset:13824
    ds_read_b64_tr_b16 a[254:255], v6 offset:13824
    v_mfma_f32_16x16x32_bf16 v[148:151], v[44:47], a[184:187], v[148:151]
    v_exp_f32_e64 v95, v95
    v_mfma_f32_16x16x32_bf16 v[156:159], v[44:47], a[208:211], v[156:159]
    ds_read_b64_tr_b16 v[44:45], v3 offset:14336
    s_waitcnt lgkmcnt(7)
    ds_read_b64_tr_b16 v[46:47], v4 offset:14336
    v_mfma_f32_16x16x32_bf16 v[148:151], v[48:51], a[188:191], v[148:151]
    v_add_f32 v21, v21, v94
    v_add_f32_e64 v21, v21, v95
    v_mfma_f32_16x16x32_bf16 v[156:159], v[48:51], a[212:215], v[156:159]
    ds_read_b64_tr_b16 v[48:49], v5 offset:14336
    ds_read_b64_tr_b16 v[50:51], v6 offset:14336
    v_mfma_f32_16x16x32_bf16 a[96:99], v[52:55], v[88:91], 0
    v_cvt_pk_bf16_f32 v93, v94, v95
    s_waitcnt vmcnt(3)
    s_add_u32 m0, s40, 49152
    s_mov_b32 s54, 24576
    buffer_load_dwordx4 v11, s[20:23], s54 offen offset:0 nt lds
    ds_write_b64 v22, v[92:93] offset:2048
    v_mfma_f32_16x16x32_bf16 a[0:3], v[52:55], v[112:115], 0
    v_exp_f32 v144, v144
    v_mfma_f32_16x16x32_bf16 a[48:51], v[52:55], v[120:123], 0
    ds_read_b64_tr_b16 v[52:53], v3 offset:14848
    ds_read_b64_tr_b16 v[54:55], v4 offset:14848
    v_mfma_f32_16x16x32_bf16 a[4:7], v[56:59], v[112:115], 0
    v_exp_f32_e64 v145, v145
    buffer_load_dwordx4 v12, s[20:23], s54 offen offset:1024 nt lds
    v_mfma_f32_16x16x32_bf16 a[52:55], v[56:59], v[120:123], 0
    ds_read_b64_tr_b16 v[56:57], v5 offset:14848
    ds_read_b64_tr_b16 v[58:59], v6 offset:14848
    v_mfma_f32_16x16x32_bf16 a[100:103], v[60:63], v[88:91], 0
    v_add_f32 v19, v19, v144
    v_add_f32 v19, v19, v145
    v_mfma_f32_16x16x32_bf16 a[8:11], v[60:63], v[112:115], 0
    v_cvt_pk_bf16_f32 v144, v144, v145
    buffer_load_dwordx4 v13, s[20:23], s54 offen offset:2048 nt lds
    v_exp_f32_e64 v146, v146
    v_mfma_f32_16x16x32_bf16 a[56:59], v[60:63], v[120:123], 0
    v_exp_f32_e64 v147, v147
    v_mfma_f32_16x16x32_bf16 a[12:15], v[64:67], v[112:115], 0
    v_add_f32 v19, v19, v146
    v_add_f32 v19, v19, v147
    v_mfma_f32_16x16x32_bf16 a[60:63], v[64:67], v[120:123], 0
    v_cvt_pk_bf16_f32 v145, v146, v147
    v_exp_f32_e64 v148, v148
    v_mfma_f32_16x16x32_bf16 a[104:107], a[240:243], v[88:91], 0
    v_exp_f32_e64 v149, v149
    v_mfma_f32_16x16x32_bf16 a[16:19], a[240:243], v[112:115], 0
    v_add_f32 v19, v19, v148
    v_add_f32 v19, v19, v149
    v_mfma_f32_16x16x32_bf16 a[64:67], a[240:243], v[120:123], 0
    v_cvt_pk_bf16_f32 v146, v148, v149
    v_exp_f32 v150, v150
    s_waitcnt lgkmcnt(0)
    v_mfma_f32_16x16x32_bf16 a[20:23], a[244:247], v[112:115], 0
    v_exp_f32_e64 v151, v151
    v_mfma_f32_16x16x32_bf16 a[68:71], a[244:247], v[120:123], 0
    v_add_f32 v19, v19, v150
    v_add_f32 v19, v19, v151
    v_mfma_f32_16x16x32_bf16 a[108:111], a[248:251], v[88:91], 0
    v_cvt_pk_bf16_f32 v147, v150, v151
    v_exp_f32_e64 v152, v152
    v_mfma_f32_16x16x32_bf16 a[24:27], a[248:251], v[112:115], 0
    v_exp_f32_e64 v153, v153
    v_mfma_f32_16x16x32_bf16 a[72:75], a[248:251], v[120:123], 0
    v_add_f32 v20, v20, v152
    v_add_f32 v20, v20, v153
    v_mfma_f32_16x16x32_bf16 a[28:31], a[252:255], v[112:115], 0
    v_cvt_pk_bf16_f32 v152, v152, v153
    v_exp_f32_e64 v154, v154
    v_mfma_f32_16x16x32_bf16 a[76:79], a[252:255], v[120:123], 0
    v_exp_f32_e64 v155, v155
    v_mfma_f32_16x16x32_bf16 a[112:115], v[44:47], v[88:91], 0
    v_add_f32 v20, v20, v154
    v_add_f32 v20, v20, v155
    v_mfma_f32_16x16x32_bf16 a[32:35], v[44:47], v[112:115], 0
    v_cvt_pk_bf16_f32 v153, v154, v155
    v_exp_f32_e64 v156, v156
    v_mfma_f32_16x16x32_bf16 a[80:83], v[44:47], v[120:123], 0
    v_exp_f32_e64 v157, v157
    v_mfma_f32_16x16x32_bf16 a[36:39], v[48:51], v[112:115], 0
    v_add_f32 v20, v20, v156
    v_add_f32 v20, v20, v157
    v_mfma_f32_16x16x32_bf16 a[84:87], v[48:51], v[120:123], 0
    v_cvt_pk_bf16_f32 v154, v156, v157
    v_exp_f32_e64 v158, v158
    v_mfma_f32_16x16x32_bf16 a[116:119], v[52:55], v[88:91], 0
    v_exp_f32_e64 v159, v159
    v_mfma_f32_16x16x32_bf16 a[40:43], v[52:55], v[112:115], 0
    v_add_f32 v20, v20, v158
    v_add_f32 v20, v20, v159
    v_mfma_f32_16x16x32_bf16 a[88:91], v[52:55], v[120:123], 0
    v_cvt_pk_bf16_f32 v155, v158, v159
    v_mfma_f32_16x16x32_bf16 a[44:47], v[56:59], v[112:115], 0
    v_mfma_f32_16x16x32_bf16 a[92:95], v[56:59], v[120:123], 0
    ds_read_b128 v[44:47], v1 offset:24576
    ds_read_b128 v[48:51], v1 offset:25088
    ds_read_b128 v[52:55], v1 offset:25600
    ds_read_b128 v[56:59], v1 offset:26112
    ds_read_b128 v[60:63], v1 offset:26624
    ds_read_b128 v[64:67], v1 offset:27136
    ds_read_b128 a[240:243], v2 offset:24576
    ds_read_b128 a[244:247], v2 offset:25088
    ds_read_b128 a[248:251], v2 offset:25600
    ds_read_b128 a[252:255], v2 offset:26112
    s_waitcnt vmcnt(3)
    ds_read_b128 v[232:235], v39 offset:0
    ds_read_b128 v[236:239], v39 offset:512
    ds_read_b128 v[240:243], v39 offset:1024
    ds_read_b128 v[244:247], v39 offset:1536
    ds_read_b128 v[248:251], v39 offset:2048
    s_waitcnt lgkmcnt(11)
    ds_read_b128 v[252:255], v39 offset:2560
    s_waitcnt lgkmcnt(5)
    v_lshlrev_b32 v24, 16, v232
    v_and_b32 v25, 4294901760, v232
    s_add_u32 m0, s40, 36864
    s_mov_b32 s54, 12288
    buffer_load_dwordx4 v14, s[24:27], s54 offen offset:0 nt lds
    v_mul_f32 v24, s52, v24
    v_mul_f32 v25, s52, v25
    v_cvt_pk_bf16_f32 v232, v24, v25
    v_lshlrev_b32_e64 v26, 16, v233
    v_and_b32 v27, 4294901760, v233
    v_mul_f32 v26, s52, v26
    v_mul_f32 v27, s52, v27
    v_cvt_pk_bf16_f32 v233, v26, v27
    buffer_load_dwordx4 v15, s[24:27], s54 offen offset:1024 nt lds
    v_lshlrev_b32_e64 v24, 16, v234
    v_and_b32 v25, 4294901760, v234
    v_mul_f32 v24, s52, v24
    v_mul_f32 v25, s52, v25
    v_cvt_pk_bf16_f32 v234, v24, v25
    v_lshlrev_b32_e64 v26, 16, v235
    v_and_b32 v27, 4294901760, v235
    v_mul_f32_e64 v26, s52, v26
    buffer_load_dwordx4 v16, s[24:27], s54 offen offset:2048 nt lds
    v_mul_f32_e64 v27, s52, v27
    v_cvt_pk_bf16_f32 v235, v26, v27
    s_waitcnt lgkmcnt(0)
    v_lshlrev_b32 v24, 16, v236
    v_and_b32 v25, 4294901760, v236
    v_mfma_f32_16x16x32_bf16 v[96:99], v[160:163], v[232:235], 0
    v_mul_f32 v24, s52, v24
    v_mul_f32 v25, s52, v25
    v_mfma_f32_16x16x32_bf16 v[100:103], v[184:187], v[232:235], 0
    v_cvt_pk_bf16_f32 v236, v24, v25
    v_lshlrev_b32_e64 v26, 16, v237
    v_and_b32 v27, 4294901760, v237
    v_mul_f32 v26, s52, v26
    v_mul_f32 v27, s52, v27
    v_cvt_pk_bf16_f32 v237, v26, v27
    v_lshlrev_b32_e64 v24, 16, v238
    v_and_b32 v25, 4294901760, v238
    v_mul_f32 v24, s52, v24
    v_mul_f32 v25, s52, v25
    v_cvt_pk_bf16_f32 v238, v24, v25
    v_lshlrev_b32_e64 v26, 16, v239
    v_and_b32 v27, 4294901760, v239
    v_mul_f32 v26, s52, v26
    v_mul_f32 v27, s52, v27
    v_cvt_pk_bf16_f32 v239, v26, v27
    v_lshlrev_b32_e64 v24, 16, v240
    v_and_b32 v25, 4294901760, v240
    v_mfma_f32_16x16x32_bf16 v[96:99], v[164:167], v[236:239], v[96:99]
    v_mul_f32 v24, s52, v24
    v_mul_f32 v25, s52, v25
    v_mfma_f32_16x16x32_bf16 v[100:103], v[188:191], v[236:239], v[100:103]
    v_cvt_pk_bf16_f32 v240, v24, v25
    v_lshlrev_b32_e64 v26, 16, v241
    v_and_b32 v27, 4294901760, v241
    v_mul_f32 v26, s52, v26
    v_mul_f32 v27, s52, v27
    v_cvt_pk_bf16_f32 v241, v26, v27
    v_lshlrev_b32_e64 v24, 16, v242
    v_and_b32 v25, 4294901760, v242
    v_mul_f32 v24, s52, v24
    v_mul_f32 v25, s52, v25
    v_cvt_pk_bf16_f32 v242, v24, v25
    v_lshlrev_b32_e64 v26, 16, v243
    v_and_b32 v27, 4294901760, v243
    v_mul_f32 v26, s52, v26
    v_mul_f32 v27, s52, v27
    v_cvt_pk_bf16_f32 v243, v26, v27
    v_lshlrev_b32_e64 v24, 16, v244
    v_and_b32 v25, 4294901760, v244
    v_mfma_f32_16x16x32_bf16 v[96:99], v[168:171], v[240:243], v[96:99]
    v_mul_f32 v24, s52, v24
    v_mul_f32 v25, s52, v25
    v_mfma_f32_16x16x32_bf16 v[100:103], v[192:195], v[240:243], v[100:103]
    v_cvt_pk_bf16_f32 v244, v24, v25
    v_lshlrev_b32_e64 v26, 16, v245
    v_and_b32 v27, 4294901760, v245
    v_mul_f32 v26, s52, v26
    v_mul_f32 v27, s52, v27
    v_cvt_pk_bf16_f32 v245, v26, v27
    v_lshlrev_b32_e64 v24, 16, v246
    v_and_b32 v25, 4294901760, v246
    v_mul_f32 v24, s52, v24
    v_mul_f32 v25, s52, v25
    v_cvt_pk_bf16_f32 v246, v24, v25
    v_lshlrev_b32_e64 v26, 16, v247
    v_and_b32 v27, 4294901760, v247
    v_mul_f32 v26, s52, v26
    v_mul_f32 v27, s52, v27
    v_cvt_pk_bf16_f32 v247, v26, v27
    v_lshlrev_b32_e64 v24, 16, v248
    v_and_b32 v25, 4294901760, v248
    v_mfma_f32_16x16x32_bf16 v[96:99], v[172:175], v[244:247], v[96:99]
    v_mul_f32 v24, s52, v24
    v_mul_f32 v25, s52, v25
    v_mfma_f32_16x16x32_bf16 v[100:103], v[196:199], v[244:247], v[100:103]
    v_cvt_pk_bf16_f32 v248, v24, v25
    v_lshlrev_b32_e64 v26, 16, v249
    v_and_b32 v27, 4294901760, v249
    v_mul_f32 v26, s52, v26
    v_mul_f32 v27, s52, v27
    v_cvt_pk_bf16_f32 v249, v26, v27
    v_lshlrev_b32_e64 v24, 16, v250
    v_and_b32 v25, 4294901760, v250
    v_mul_f32 v24, s52, v24
    v_mul_f32 v25, s52, v25
    v_cvt_pk_bf16_f32 v250, v24, v25
    v_lshlrev_b32_e64 v26, 16, v251
    v_and_b32 v27, 4294901760, v251
    v_mul_f32 v26, s52, v26
    v_mul_f32 v27, s52, v27
    v_cvt_pk_bf16_f32 v251, v26, v27
    v_lshlrev_b32_e64 v24, 16, v252
    v_and_b32 v25, 4294901760, v252
    v_mfma_f32_16x16x32_bf16 v[96:99], v[176:179], v[248:251], v[96:99]
    v_mul_f32 v24, s52, v24
    v_mul_f32 v25, s52, v25
    v_mfma_f32_16x16x32_bf16 v[100:103], v[200:203], v[248:251], v[100:103]
    v_cvt_pk_bf16_f32 v252, v24, v25
    v_lshlrev_b32_e64 v26, 16, v253
    v_and_b32 v27, 4294901760, v253
    v_mul_f32 v26, s52, v26
    v_mul_f32 v27, s52, v27
    v_cvt_pk_bf16_f32 v253, v26, v27
    v_lshlrev_b32_e64 v24, 16, v254
    v_and_b32 v25, 4294901760, v254
    v_mul_f32 v24, s52, v24
    v_mul_f32 v25, s52, v25
    v_cvt_pk_bf16_f32 v254, v24, v25
    v_lshlrev_b32_e64 v26, 16, v255
    v_and_b32 v27, 4294901760, v255
    v_mul_f32 v26, s52, v26
    s_waitcnt vmcnt(3)
    s_add_u32 m0, s40, 122880
    s_mov_b32 s54, 6144
    buffer_load_dwordx4 v32, s[16:19], s54 offen offset:0 nt lds
    v_mul_f32_e64 v27, s52, v27
    v_cvt_pk_bf16_f32 v255, v26, v27
    v_accvgpr_write_b32 a120, v232
    v_accvgpr_write_b32 a121, v233
    v_mfma_f32_16x16x32_bf16 v[96:99], v[180:183], v[252:255], v[96:99]
    v_accvgpr_write_b32 a122, v234
    v_accvgpr_write_b32 a123, v235
    v_mfma_f32_16x16x32_bf16 v[100:103], v[204:207], v[252:255], v[100:103]
    buffer_load_dwordx4 v33, s[16:19], s54 offen offset:1024 nt lds
    v_accvgpr_write_b32 a124, v236
    v_accvgpr_write_b32 a125, v237
    v_accvgpr_write_b32 a126, v238
    v_accvgpr_write_b32 a127, v239
    v_accvgpr_write_b32 a128, v240
    v_max3_f32 v28, v96, v97, v98
    v_accvgpr_write_b32 a129, v241
    v_accvgpr_write_b32 a130, v242
    buffer_load_dwordx4 v34, s[16:19], s54 offen offset:2048 nt lds
    v_accvgpr_write_b32 a131, v243
    v_max3_f32 v28, v28, v99, v100
    v_max3_f32 v28, v28, v101, v102
    v_max_f32 v28, v28, v103
    v_mov_b32 v29, v28
    v_accvgpr_write_b32 a132, v244
    v_accvgpr_write_b32 a133, v245
    v_permlane16_swap_b32 v28, v29
    v_max_f32 v28, v28, v29
    v_mov_b32_e64 v29, v28
    v_accvgpr_write_b32 a134, v246
    v_accvgpr_write_b32 a135, v247
    v_permlane32_swap_b32 v28, v29
    v_max_f32 v28, v28, v29
    v_sub_f32 v68, 0, v28
    v_sub_f32 v69, 0, v28
    v_sub_f32 v70, 0, v28
    v_sub_f32 v71, 0, v28
    v_sub_f32 v96, v96, v28
    v_sub_f32 v97, v97, v28
    v_mfma_f32_16x16x32_bf16 v[128:131], v[44:47], a[120:123], v[68:71]
    v_sub_f32 v98, v98, v28
    v_sub_f32 v99, v99, v28
    v_mfma_f32_16x16x32_bf16 v[128:131], v[48:51], a[124:127], v[128:131]
    v_sub_f32 v100, v100, v28
    v_sub_f32 v101, v101, v28
    v_mfma_f32_16x16x32_bf16 v[128:131], v[52:55], a[128:131], v[128:131]
    v_sub_f32 v102, v102, v28
    v_sub_f32 v103, v103, v28
    v_mfma_f32_16x16x32_bf16 v[128:131], v[56:59], a[132:135], v[128:131]
    v_accvgpr_write_b32 a136, v248
    v_accvgpr_write_b32 a137, v249
    v_mfma_f32_16x16x32_bf16 v[132:135], a[240:243], a[120:123], v[68:71]
    v_accvgpr_write_b32 a138, v250
    v_accvgpr_write_b32 a139, v251
    v_mfma_f32_16x16x32_bf16 v[132:135], a[244:247], a[124:127], v[132:135]
    v_accvgpr_write_b32 a140, v252
    v_accvgpr_write_b32 a141, v253
    v_mfma_f32_16x16x32_bf16 v[128:131], v[60:63], a[136:139], v[128:131]
    v_accvgpr_write_b32 a142, v254
    v_accvgpr_write_b32 a143, v255
    v_mfma_f32_16x16x32_bf16 v[132:135], a[248:251], a[128:131], v[132:135]
    v_exp_f32_e64 v96, v96
    v_mfma_f32_16x16x32_bf16 v[128:131], v[64:67], a[140:143], v[128:131]
    v_exp_f32_e64 v97, v97
    v_mfma_f32_16x16x32_bf16 v[132:135], a[252:255], a[132:135], v[132:135]
    v_add_f32 v17, v17, v96
    v_add_f32 v17, v17, v97
    v_cvt_pk_bf16_f32 v96, v96, v97
    v_exp_f32 v98, v98
    v_exp_f32 v99, v99
    v_add_f32 v17, v17, v98
    v_add_f32 v17, v17, v99
    v_cvt_pk_bf16_f32 v97, v98, v99
    v_exp_f32 v100, v100
    v_exp_f32 v101, v101
    v_add_f32 v17, v17, v100
    v_add_f32 v17, v17, v101
    v_cvt_pk_bf16_f32 v98, v100, v101
    v_exp_f32 v102, v102
    v_exp_f32 v103, v103
    v_add_f32 v17, v17, v102
    v_add_f32 v17, v17, v103
    v_cvt_pk_bf16_f32 v99, v102, v103
    ds_read_b128 v[44:47], v2 offset:26624
    ds_read_b128 v[48:51], v2 offset:27136
    ds_read_b64_tr_b16 v[52:53], v3 offset:12288
    ds_read_b64_tr_b16 v[54:55], v4 offset:12288
    ds_read_b64_tr_b16 v[56:57], v5 offset:12288
    ds_read_b64_tr_b16 v[58:59], v6 offset:12288
    ds_read_b64_tr_b16 v[60:61], v3 offset:12800
    ds_read_b64_tr_b16 v[62:63], v4 offset:12800
    ds_read_b64_tr_b16 v[64:65], v5 offset:12800
    ds_read_b64_tr_b16 v[66:67], v6 offset:12800
    ds_read_b64_tr_b16 a[240:241], v3 offset:13312
    ds_read_b64_tr_b16 a[242:243], v4 offset:13312
    ds_read_b64_tr_b16 a[244:245], v5 offset:13312
    ds_read_b64_tr_b16 a[246:247], v6 offset:13312
    ds_read_b64_tr_b16 a[248:249], v3 offset:13824
    s_waitcnt lgkmcnt(11)
    ds_read_b64_tr_b16 a[250:251], v4 offset:13824
    ds_read_b64_tr_b16 a[252:253], v5 offset:13824
    ds_read_b64_tr_b16 a[254:255], v6 offset:13824
    v_exp_f32 v128, v128
    v_exp_f32 v129, v129
    v_add_f32 v17, v17, v128
    v_add_f32_e64 v17, v17, v129
    v_cvt_pk_bf16_f32 v128, v128, v129
    v_exp_f32 v130, v130
    v_exp_f32 v131, v131
    v_add_f32 v17, v17, v130
    v_add_f32 v17, v17, v131
    v_cvt_pk_bf16_f32 v129, v130, v131
    v_mfma_f32_16x16x32_bf16 v[132:135], v[44:47], a[136:139], v[132:135]
    ds_read_b64_tr_b16 v[44:45], v3 offset:14336
    s_waitcnt lgkmcnt(7)
    ds_read_b64_tr_b16 v[46:47], v4 offset:14336
    v_mfma_f32_16x16x32_bf16 v[132:135], v[48:51], a[140:143], v[132:135]
    ds_read_b64_tr_b16 v[48:49], v5 offset:14336
    ds_read_b64_tr_b16 v[50:51], v6 offset:14336
    v_mfma_f32_16x16x32_bf16 v[160:163], v[52:55], v[96:99], 0
    ds_read_b64_tr_b16 v[52:53], v3 offset:14848
    ds_read_b64_tr_b16 v[54:55], v4 offset:14848
    v_mfma_f32_16x16x32_bf16 v[164:167], v[56:59], v[96:99], 0
    ds_read_b64_tr_b16 v[56:57], v5 offset:14848
    ds_read_b64_tr_b16 v[58:59], v6 offset:14848
    v_mfma_f32_16x16x32_bf16 v[168:171], v[60:63], v[96:99], 0
    v_exp_f32 v132, v132
    v_mfma_f32_16x16x32_bf16 v[172:175], v[64:67], v[96:99], 0
    v_exp_f32_e64 v133, v133
    v_mfma_f32_16x16x32_bf16 v[176:179], a[240:243], v[96:99], 0
    v_add_f32_e64 v17, v17, v132
    v_add_f32 v17, v17, v133
    s_waitcnt lgkmcnt(8)
    v_mfma_f32_16x16x32_bf16 v[180:183], a[244:247], v[96:99], 0
    v_cvt_pk_bf16_f32 v130, v132, v133
    v_exp_f32_e64 v134, v134
    v_mfma_f32_16x16x32_bf16 v[184:187], a[248:251], v[96:99], 0
    v_exp_f32_e64 v135, v135
    v_mfma_f32_16x16x32_bf16 v[188:191], a[252:255], v[96:99], 0
    v_add_f32_e64 v17, v17, v134
    v_add_f32 v17, v17, v135
    s_waitcnt lgkmcnt(2)
    v_mfma_f32_16x16x32_bf16 v[192:195], v[44:47], v[96:99], 0
    v_cvt_pk_bf16_f32 v131, v134, v135
    v_mfma_f32_16x16x32_bf16 v[196:199], v[48:51], v[96:99], 0
    v_mfma_f32_16x16x32_bf16 v[200:203], v[52:55], v[96:99], 0
    s_waitcnt lgkmcnt(0)
    v_mfma_f32_16x16x32_bf16 v[204:207], v[56:59], v[96:99], 0
    s_waitcnt lgkmcnt(0)
    s_waitcnt vmcnt(3)
    s_add_u32 m0, s40, 135168
    s_mov_b32 s54, 9216
    buffer_load_dwordx4 v35, s[16:19], s54 offen offset:0 nt lds
    buffer_load_dwordx4 v36, s[16:19], s54 offen offset:1024 nt lds
    buffer_load_dwordx4 v37, s[16:19], s54 offen offset:2048 nt lds
    s_barrier
    ds_read_b64 v[94:95], v23 offset:2048
    ds_read_b128 v[44:47], v1 offset:49152
    ds_read_b128 v[48:51], v1 offset:49664
    ds_read_b128 v[52:55], v1 offset:50176
    ds_read_b128 v[56:59], v1 offset:50688
    ds_read_b128 v[60:63], v1 offset:51200
    ds_read_b128 v[64:67], v1 offset:51712
    ds_read_b128 a[240:243], v2 offset:49152
    ds_read_b128 a[244:247], v2 offset:49664
    ds_read_b128 a[248:251], v2 offset:50176
    ds_read_b128 a[252:255], v2 offset:50688
    s_waitcnt lgkmcnt(9)
    v_mfma_f32_16x16x32_bf16 v[88:91], v[44:47], a[216:219], v[84:87]
    v_and_b32 v24, 7, v0
    v_lshrrev_b32_e64 v25, 5, v0
    v_mfma_f32_16x16x32_bf16 v[96:99], v[44:47], a[120:123], v[68:71]
    v_xor_b32_e64 v25, v25, v24
    v_mul_u32_u24 v24, 384, v24
    v_mfma_f32_16x16x32_bf16 v[112:115], v[44:47], a[168:171], v[76:79]
    v_lshl_add_u32 v24, v25, 4, v24
    v_bfe_u32 v25, v0, 4, 1
    v_mfma_f32_16x16x32_bf16 v[120:123], v[44:47], a[192:195], v[80:83]
    ds_read_b128 v[44:47], v2 offset:51200
    v_lshl_add_u32 v24, v25, 3, v24
    s_waitcnt lgkmcnt(7)
    v_mfma_f32_16x16x32_bf16 v[88:91], v[48:51], a[220:223], v[88:91]
    s_lshl_b32 s69, s50, 6
    v_xor_b32_e64 v24, s69, v24
    v_mfma_f32_16x16x32_bf16 v[96:99], v[48:51], a[124:127], v[96:99]
    v_bfe_u32 v25, v0, 3, 1
    v_mul_u32_u24 v26, 12288, v25
    v_mfma_f32_16x16x32_bf16 v[112:115], v[48:51], a[172:175], v[112:115]
    v_add3_u32 v32, v24, v26, s40
    v_xor_b32_e64 v33, 64, v32
    v_mfma_f32_16x16x32_bf16 v[120:123], v[48:51], a[196:199], v[120:123]
    ds_read_b128 v[48:51], v2 offset:51712
    v_xor_b32_e64 v34, 32, v32
    v_mfma_f32_16x16x32_bf16 v[88:91], v[52:55], a[224:227], v[88:91]
    v_xor_b32 v35, 96, v32
    v_lshrrev_b32_e64 v24, 3, v0
    v_mfma_f32_16x16x32_bf16 v[96:99], v[52:55], a[128:131], v[96:99]
    v_and_b32 v25, 7, v0
    v_xor_b32 v26, v25, v24
    v_mfma_f32_16x16x32_bf16 v[112:115], v[52:55], a[176:179], v[112:115]
    v_mul_u32_u24 v24, 384, v24
    v_lshl_add_u32 v26, v26, 4, v24
    v_mfma_f32_16x16x32_bf16 v[120:123], v[52:55], a[200:203], v[120:123]
    ds_read_b64_tr_b16 v[52:53], v3 offset:36864
    ds_read_b64_tr_b16 v[54:55], v4 offset:36864
    v_mfma_f32_16x16x32_bf16 v[88:91], v[56:59], a[228:231], v[88:91]
    v_add_u32_e64 v36, s40, v26
    s_mul_i32 s70, s3, 24576
    v_mfma_f32_16x16x32_bf16 v[96:99], v[56:59], a[132:135], v[96:99]
    v_lshl_add_u32 v25, v25, 4, v24
    v_add_u32_e64 v37, s70, v25
    v_mfma_f32_16x16x32_bf16 v[112:115], v[56:59], a[180:183], v[112:115]
    v_and_b32_e64 v24, 15, v0
    v_bfe_u32 v25, v0, 1, 2
    v_mfma_f32_16x16x32_bf16 v[120:123], v[56:59], a[204:207], v[120:123]
    ds_read_b64_tr_b16 v[56:57], v5 offset:36864
    ds_read_b64_tr_b16 v[58:59], v6 offset:36864
    s_waitcnt lgkmcnt(4)
    v_mfma_f32_16x16x32_bf16 v[88:91], v[60:63], a[232:235], v[88:91]
    v_lshrrev_b32 v26, 5, v0
    v_xor_b32_e64 v25, v25, v26
    v_mfma_f32_16x16x32_bf16 v[96:99], v[60:63], a[136:139], v[96:99]
    v_lshlrev_b32_e64 v24, 6, v24
    v_lshl_add_u32 v24, v25, 4, v24
    v_mfma_f32_16x16x32_bf16 v[112:115], v[60:63], a[184:187], v[112:115]
    v_bfe_u32 v25, v0, 4, 1
    v_lshl_add_u32 v24, v25, 3, v24
    v_mfma_f32_16x16x32_bf16 v[120:123], v[60:63], a[208:211], v[120:123]
    ds_read_b64_tr_b16 v[60:61], v3 offset:37376
    ds_read_b64_tr_b16 v[62:63], v4 offset:37376
    v_mfma_f32_16x16x32_bf16 v[88:91], v[64:67], a[236:239], v[88:91]
    s_add_u32 s69, s40, 98304
    v_add_u32_e64 v30, s69, v24
    v_mfma_f32_16x16x32_bf16 v[96:99], v[64:67], a[140:143], v[96:99]
    v_bfe_u32 v24, v0, 3, 2
    v_xor_b32_e64 v24, v24, v0
    v_mfma_f32_16x16x32_bf16 v[112:115], v[64:67], a[188:191], v[112:115]
    v_lshlrev_b32 v24, 4, v24
    v_add_u32 v31, s69, v24
    v_mfma_f32_16x16x32_bf16 v[120:123], v[64:67], a[212:215], v[120:123]
    ds_read_b64_tr_b16 v[64:65], v5 offset:37376
    ds_read_b64_tr_b16 v[66:67], v6 offset:37376
    v_mfma_f32_16x16x32_bf16 v[100:103], a[240:243], a[120:123], v[68:71]
    v_lshrrev_b32_e64 v24, 2, v0
    v_mul_u32_u24 v24, 384, v24
    v_mfma_f32_16x16x32_bf16 v[116:119], a[240:243], a[168:171], v[76:79]
    v_and_b32_e64 v25, 3, v0
    v_lshl_add_u32 v24, v25, 4, v24
    v_mfma_f32_16x16x32_bf16 v[124:127], a[240:243], a[192:195], v[80:83]
    ds_read_b64_tr_b16 a[240:241], v3 offset:37888
    ds_read_b64_tr_b16 a[242:243], v4 offset:37888
    v_mfma_f32_16x16x32_bf16 v[100:103], a[244:247], a[124:127], v[100:103]
    s_mul_i32 s69, s49, 6144
    s_lshl_b32 s70, s50, 6
    v_mfma_f32_16x16x32_bf16 v[116:119], a[244:247], a[172:175], v[116:119]
    s_add_u32 s69, s69, s70
    s_add_u32 s69, s69, 98304
    v_mfma_f32_16x16x32_bf16 v[124:127], a[244:247], a[196:199], v[124:127]
    ds_read_b64_tr_b16 a[244:245], v5 offset:37888
    ds_read_b64_tr_b16 a[246:247], v6 offset:37888
    v_mfma_f32_16x16x32_bf16 v[100:103], a[248:251], a[128:131], v[100:103]
    v_add_u32 v40, s69, v24
    s_lshl_b32 s69, s3, 8
    v_mfma_f32_16x16x32_bf16 v[116:119], a[248:251], a[176:179], v[116:119]
    s_add_u32 s69, s69, 147456
    v_lshlrev_b32_e64 v24, 2, v0
    v_mfma_f32_16x16x32_bf16 v[124:127], a[248:251], a[200:203], v[124:127]
    ds_read_b64_tr_b16 a[248:249], v3 offset:38400
    ds_read_b64_tr_b16 a[250:251], v4 offset:38400
    v_mfma_f32_16x16x32_bf16 v[100:103], a[252:255], a[132:135], v[100:103]
    v_add_u32 v41, s69, v24
    v_exp_f32 v88, v88
    v_mfma_f32_16x16x32_bf16 v[116:119], a[252:255], a[180:183], v[116:119]
    v_exp_f32_e64 v89, v89
    v_mfma_f32_16x16x32_bf16 v[124:127], a[252:255], a[204:207], v[124:127]
    ds_read_b64_tr_b16 a[252:253], v5 offset:38400
    s_waitcnt lgkmcnt(5)
    ds_read_b64_tr_b16 a[254:255], v6 offset:38400
    v_mfma_f32_16x16x32_bf16 v[100:103], v[44:47], a[136:139], v[100:103]
    v_add_f32 v21, v21, v88
    v_add_f32_e64 v21, v21, v89
    v_mfma_f32_16x16x32_bf16 v[116:119], v[44:47], a[184:187], v[116:119]
    v_cvt_pk_bf16_f32 v88, v88, v89
    v_exp_f32_e64 v90, v90
    v_mfma_f32_16x16x32_bf16 v[124:127], v[44:47], a[208:211], v[124:127]
    s_waitcnt vmcnt(3)
    s_add_u32 m0, s40, 73728
    s_mov_b32 s54, 36864
    buffer_load_dwordx4 v11, s[20:23], s54 offen offset:0 nt lds
    ds_read_b64_tr_b16 v[44:45], v3 offset:38912
    ds_read_b64_tr_b16 v[46:47], v4 offset:38912
    v_mfma_f32_16x16x32_bf16 v[100:103], v[48:51], a[140:143], v[100:103]
    v_exp_f32 v91, v91
    v_mfma_f32_16x16x32_bf16 v[116:119], v[48:51], a[188:191], v[116:119]
    v_add_f32 v21, v21, v90
    v_add_f32 v21, v21, v91
    v_mfma_f32_16x16x32_bf16 v[124:127], v[48:51], a[212:215], v[124:127]
    buffer_load_dwordx4 v12, s[20:23], s54 offen offset:1024 nt lds
    ds_read_b64_tr_b16 v[48:49], v5 offset:38912
    ds_read_b64_tr_b16 v[50:51], v6 offset:38912
    v_mfma_f32_16x16x32_bf16 v[160:163], v[52:55], v[128:131], v[160:163]
    v_cvt_pk_bf16_f32 v89, v90, v91
    ds_write_b64 v22, v[88:89] offset:0
    v_mfma_f32_16x16x32_bf16 a[0:3], v[52:55], v[144:147], a[0:3]
    v_mfma_f32_16x16x32_bf16 a[48:51], v[52:55], v[152:155], a[48:51]
    v_mfma_f32_16x16x32_bf16 a[96:99], v[52:55], v[92:95], a[96:99]
    buffer_load_dwordx4 v13, s[20:23], s54 offen offset:2048 nt lds
    ds_read_b64_tr_b16 v[52:53], v3 offset:39424
    ds_read_b64_tr_b16 v[54:55], v4 offset:39424
    v_mfma_f32_16x16x32_bf16 v[164:167], v[56:59], v[128:131], v[164:167]
    v_mfma_f32_16x16x32_bf16 a[4:7], v[56:59], v[144:147], a[4:7]
    v_mfma_f32_16x16x32_bf16 a[52:55], v[56:59], v[152:155], a[52:55]
    ds_read_b64_tr_b16 v[56:57], v5 offset:39424
    ds_read_b64_tr_b16 v[58:59], v6 offset:39424
    v_mfma_f32_16x16x32_bf16 v[168:171], v[60:63], v[128:131], v[168:171]
    v_mfma_f32_16x16x32_bf16 a[8:11], v[60:63], v[144:147], a[8:11]
    v_mfma_f32_16x16x32_bf16 a[56:59], v[60:63], v[152:155], a[56:59]
    v_mfma_f32_16x16x32_bf16 a[100:103], v[60:63], v[92:95], a[100:103]
    s_waitcnt lgkmcnt(6)
    ds_read_b128 v[60:63], v1 offset:0
    v_mfma_f32_16x16x32_bf16 v[172:175], v[64:67], v[128:131], v[172:175]
    v_mfma_f32_16x16x32_bf16 a[12:15], v[64:67], v[144:147], a[12:15]
    v_mfma_f32_16x16x32_bf16 a[60:63], v[64:67], v[152:155], a[60:63]
    ds_read_b128 v[64:67], v2 offset:0
    v_mfma_f32_16x16x32_bf16 v[176:179], a[240:243], v[128:131], v[176:179]
    v_mfma_f32_16x16x32_bf16 a[16:19], a[240:243], v[144:147], a[16:19]
    v_mfma_f32_16x16x32_bf16 a[64:67], a[240:243], v[152:155], a[64:67]
    v_mfma_f32_16x16x32_bf16 a[104:107], a[240:243], v[92:95], a[104:107]
    ds_read_b128 a[240:243], v1 offset:512
    v_mfma_f32_16x16x32_bf16 v[180:183], a[244:247], v[128:131], v[180:183]
    v_mfma_f32_16x16x32_bf16 a[20:23], a[244:247], v[144:147], a[20:23]
    v_mfma_f32_16x16x32_bf16 a[68:71], a[244:247], v[152:155], a[68:71]
    ds_read_b128 a[244:247], v2 offset:512
    v_mfma_f32_16x16x32_bf16 v[184:187], a[248:251], v[128:131], v[184:187]
    v_mfma_f32_16x16x32_bf16 a[24:27], a[248:251], v[144:147], a[24:27]
    v_mfma_f32_16x16x32_bf16 a[72:75], a[248:251], v[152:155], a[72:75]
    v_mfma_f32_16x16x32_bf16 a[108:111], a[248:251], v[92:95], a[108:111]
    ds_read_b128 a[248:251], v1 offset:1024
    v_mfma_f32_16x16x32_bf16 v[188:191], a[252:255], v[128:131], v[188:191]
    v_mfma_f32_16x16x32_bf16 a[28:31], a[252:255], v[144:147], a[28:31]
    v_mfma_f32_16x16x32_bf16 a[76:79], a[252:255], v[152:155], a[76:79]
    ds_read_b128 a[252:255], v2 offset:1024
    v_mfma_f32_16x16x32_bf16 v[192:195], v[44:47], v[128:131], v[192:195]
    v_mfma_f32_16x16x32_bf16 a[32:35], v[44:47], v[144:147], a[32:35]
    v_mfma_f32_16x16x32_bf16 a[80:83], v[44:47], v[152:155], a[80:83]
    v_mfma_f32_16x16x32_bf16 a[112:115], v[44:47], v[92:95], a[112:115]
    ds_read_b128 v[44:47], v1 offset:1536
    s_waitcnt lgkmcnt(5)
    v_mfma_f32_16x16x32_bf16 v[196:199], v[48:51], v[128:131], v[196:199]
    v_mfma_f32_16x16x32_bf16 a[36:39], v[48:51], v[144:147], a[36:39]
    v_mfma_f32_16x16x32_bf16 a[84:87], v[48:51], v[152:155], a[84:87]
    ds_read_b128 v[48:51], v2 offset:1536
    v_mfma_f32_16x16x32_bf16 v[200:203], v[52:55], v[128:131], v[200:203]
    v_mfma_f32_16x16x32_bf16 a[40:43], v[52:55], v[144:147], a[40:43]
    s_waitcnt vmcnt(3)
    ds_read_b128 v[232:235], v39 offset:24576
    v_mfma_f32_16x16x32_bf16 a[88:91], v[52:55], v[152:155], a[88:91]
    ds_read_b128 v[236:239], v39 offset:25088
    ds_read_b128 v[240:243], v39 offset:25600
    v_mfma_f32_16x16x32_bf16 a[116:119], v[52:55], v[92:95], a[116:119]
    ds_read_b128 v[244:247], v39 offset:26112
    ds_read_b128 v[248:251], v39 offset:26624
    v_mfma_f32_16x16x32_bf16 v[204:207], v[56:59], v[128:131], v[204:207]
    ds_read_b128 v[252:255], v39 offset:27136
    ds_read_b128 v[52:55], v1 offset:2048
    v_mfma_f32_16x16x32_bf16 a[44:47], v[56:59], v[144:147], a[44:47]
    v_mfma_f32_16x16x32_bf16 a[92:95], v[56:59], v[152:155], a[92:95]
    s_add_u32 m0, s40, 61440
    s_mov_b32 s54, 24576
    buffer_load_dwordx4 v14, s[24:27], s54 offen offset:0 nt lds
    ds_read_b128 v[56:59], v2 offset:2048
    s_waitcnt lgkmcnt(7)
    v_lshlrev_b32_e64 v24, 16, v232
    v_and_b32 v25, 4294901760, v232
    v_mul_f32 v24, s52, v24
    v_mul_f32 v25, s52, v25
    v_cvt_pk_bf16_f32 v232, v24, v25
    v_lshlrev_b32_e64 v26, 16, v233
    v_and_b32 v27, 4294901760, v233
    buffer_load_dwordx4 v15, s[24:27], s54 offen offset:1024 nt lds
    v_mul_f32 v26, s52, v26
    v_mul_f32 v27, s52, v27
    v_cvt_pk_bf16_f32 v233, v26, v27
    v_lshlrev_b32_e64 v24, 16, v234
    v_and_b32 v25, 4294901760, v234
    v_mul_f32 v24, s52, v24
    v_mul_f32 v25, s52, v25
    v_cvt_pk_bf16_f32 v234, v24, v25
    buffer_load_dwordx4 v16, s[24:27], s54 offen offset:2048 nt lds
    v_lshlrev_b32_e64 v26, 16, v235
    v_and_b32 v27, 4294901760, v235
    v_mul_f32 v26, s52, v26
    v_mul_f32 v27, s52, v27
    v_cvt_pk_bf16_f32 v235, v26, v27
    s_waitcnt lgkmcnt(0)
    v_lshlrev_b32 v24, 16, v236
    v_and_b32 v25, 4294901760, v236
    v_mfma_f32_16x16x32_bf16 v[104:107], v[60:63], v[232:235], 0
    ds_read_b128 v[60:63], v1 offset:2560
    v_mul_f32_e64 v24, s52, v24
    v_mfma_f32_16x16x32_bf16 v[108:111], v[64:67], v[232:235], 0
    ds_read_b128 v[64:67], v2 offset:2560
    v_mul_f32_e64 v25, s52, v25
    v_cvt_pk_bf16_f32 v236, v24, v25
    v_lshlrev_b32_e64 v26, 16, v237
    v_and_b32 v27, 4294901760, v237
    v_mul_f32 v26, s52, v26
    v_mul_f32 v27, s52, v27
    v_cvt_pk_bf16_f32 v237, v26, v27
    v_lshlrev_b32_e64 v24, 16, v238
    v_and_b32 v25, 4294901760, v238
    v_mul_f32 v24, s52, v24
    v_mul_f32 v25, s52, v25
    v_cvt_pk_bf16_f32 v238, v24, v25
    v_lshlrev_b32_e64 v26, 16, v239
    v_and_b32 v27, 4294901760, v239
    v_mul_f32 v26, s52, v26
    v_mul_f32 v27, s52, v27
    v_cvt_pk_bf16_f32 v239, v26, v27
    v_lshlrev_b32_e64 v24, 16, v240
    v_and_b32 v25, 4294901760, v240
    v_mfma_f32_16x16x32_bf16 v[104:107], a[240:243], v[236:239], v[104:107]
    ds_read_b128 a[240:243], v1 offset:24576
    v_mul_f32_e64 v24, s52, v24
    v_mfma_f32_16x16x32_bf16 v[108:111], a[244:247], v[236:239], v[108:111]
    ds_read_b128 a[244:247], v1 offset:25088
    v_mul_f32_e64 v25, s52, v25
    v_cvt_pk_bf16_f32 v240, v24, v25
    v_lshlrev_b32_e64 v26, 16, v241
    v_and_b32 v27, 4294901760, v241
    v_mul_f32 v26, s52, v26
    v_mul_f32 v27, s52, v27
    v_cvt_pk_bf16_f32 v241, v26, v27
    v_lshlrev_b32_e64 v24, 16, v242
    v_and_b32 v25, 4294901760, v242
    v_mul_f32 v24, s52, v24
    v_mul_f32 v25, s52, v25
    v_cvt_pk_bf16_f32 v242, v24, v25
    v_lshlrev_b32_e64 v26, 16, v243
    v_and_b32 v27, 4294901760, v243
    v_mul_f32 v26, s52, v26
    v_mul_f32 v27, s52, v27
    v_cvt_pk_bf16_f32 v243, v26, v27
    v_lshlrev_b32_e64 v24, 16, v244
    v_and_b32 v25, 4294901760, v244
    v_mfma_f32_16x16x32_bf16 v[104:107], a[248:251], v[240:243], v[104:107]
    ds_read_b128 a[248:251], v1 offset:25600
    v_mul_f32_e64 v24, s52, v24
    v_mfma_f32_16x16x32_bf16 v[108:111], a[252:255], v[240:243], v[108:111]
    ds_read_b128 a[252:255], v1 offset:26112
    v_mul_f32_e64 v25, s52, v25
    v_cvt_pk_bf16_f32 v244, v24, v25
    v_lshlrev_b32_e64 v26, 16, v245
    v_and_b32 v27, 4294901760, v245
    v_mul_f32 v26, s52, v26
    v_mul_f32 v27, s52, v27
    v_cvt_pk_bf16_f32 v245, v26, v27
    v_lshlrev_b32_e64 v24, 16, v246
    v_and_b32 v25, 4294901760, v246
    v_mul_f32 v24, s52, v24
    v_mul_f32 v25, s52, v25
    v_cvt_pk_bf16_f32 v246, v24, v25
    v_lshlrev_b32_e64 v26, 16, v247
    v_and_b32 v27, 4294901760, v247
    v_mul_f32 v26, s52, v26
    v_mul_f32 v27, s52, v27
    v_cvt_pk_bf16_f32 v247, v26, v27
    v_lshlrev_b32_e64 v24, 16, v248
    v_and_b32 v25, 4294901760, v248
    v_mfma_f32_16x16x32_bf16 v[104:107], v[44:47], v[244:247], v[104:107]
    ds_read_b128 v[44:47], v1 offset:26624
    v_mul_f32_e64 v24, s52, v24
    v_mfma_f32_16x16x32_bf16 v[108:111], v[48:51], v[244:247], v[108:111]
    ds_read_b128 v[48:51], v1 offset:27136
    v_mul_f32_e64 v25, s52, v25
    v_cvt_pk_bf16_f32 v248, v24, v25
    v_lshlrev_b32_e64 v26, 16, v249
    v_and_b32 v27, 4294901760, v249
    v_mul_f32 v26, s52, v26
    v_mul_f32 v27, s52, v27
    v_cvt_pk_bf16_f32 v249, v26, v27
    v_lshlrev_b32_e64 v24, 16, v250
    v_and_b32 v25, 4294901760, v250
    v_mul_f32 v24, s52, v24
    v_mul_f32 v25, s52, v25
    v_cvt_pk_bf16_f32 v250, v24, v25
    v_lshlrev_b32_e64 v26, 16, v251
    v_and_b32 v27, 4294901760, v251
    v_mul_f32 v26, s52, v26
    v_mul_f32 v27, s52, v27
    v_cvt_pk_bf16_f32 v251, v26, v27
    v_lshlrev_b32_e64 v24, 16, v252
    v_and_b32 v25, 4294901760, v252
    v_mfma_f32_16x16x32_bf16 v[104:107], v[52:55], v[248:251], v[104:107]
    ds_read_b128 v[52:55], v2 offset:24576
    v_mul_f32_e64 v24, s52, v24
    v_mfma_f32_16x16x32_bf16 v[108:111], v[56:59], v[248:251], v[108:111]
    ds_read_b128 v[56:59], v2 offset:25088
    v_mul_f32_e64 v25, s52, v25
    v_cvt_pk_bf16_f32 v252, v24, v25
    v_lshlrev_b32_e64 v26, 16, v253
    v_and_b32 v27, 4294901760, v253
    v_mul_f32 v26, s52, v26
    v_mul_f32 v27, s52, v27
    v_cvt_pk_bf16_f32 v253, v26, v27
    v_lshlrev_b32_e64 v24, 16, v254
    v_and_b32 v25, 4294901760, v254
    v_mul_f32 v24, s52, v24
    v_mul_f32 v25, s52, v25
    v_cvt_pk_bf16_f32 v254, v24, v25
    v_lshlrev_b32_e64 v26, 16, v255
    v_and_b32 v27, 4294901760, v255
    v_mul_f32 v26, s52, v26
    v_mul_f32 v27, s52, v27
    v_cvt_pk_bf16_f32 v255, v26, v27
    v_accvgpr_write_b32 a144, v232
    v_accvgpr_write_b32 a145, v233
    s_waitcnt lgkmcnt(0)
    v_mfma_f32_16x16x32_bf16 v[104:107], v[60:63], v[252:255], v[104:107]
    ds_read_b128 v[60:63], v2 offset:25600
    v_accvgpr_write_b32 a146, v234
    v_mfma_f32_16x16x32_bf16 v[108:111], v[64:67], v[252:255], v[108:111]
    ds_read_b128 v[64:67], v2 offset:26112
    v_accvgpr_write_b32 a147, v235
    v_accvgpr_write_b32 a148, v236
    v_accvgpr_write_b32 a149, v237
    v_accvgpr_write_b32 a150, v238
    v_max3_f32 v28, v104, v105, v106
    s_waitcnt vmcnt(3)
    s_add_u32 m0, s40, 86016
    s_mov_b32 s54, 36864
    buffer_load_dwordx4 v14, s[24:27], s54 offen offset:0 nt lds
    v_accvgpr_write_b32 a151, v239
    v_accvgpr_write_b32 a152, v240
    v_accvgpr_write_b32 a153, v241
    v_max3_f32 v28, v28, v107, v108
    v_max3_f32 v28, v28, v109, v110
    v_max_f32 v28, v28, v111
    v_mov_b32 v29, v28
    v_accvgpr_write_b32 a154, v242
    buffer_load_dwordx4 v15, s[24:27], s54 offen offset:1024 nt lds
    v_accvgpr_write_b32 a155, v243
    v_permlane16_swap_b32 v28, v29
    v_max_f32 v28, v28, v29
    v_mov_b32_e64 v29, v28
    v_accvgpr_write_b32 a156, v244
    v_accvgpr_write_b32 a157, v245
    v_permlane32_swap_b32 v28, v29
    v_max_f32 v28, v28, v29
    buffer_load_dwordx4 v16, s[24:27], s54 offen offset:2048 nt lds
    v_sub_f32 v72, 0, v28
    v_sub_f32 v73, 0, v28
    v_sub_f32 v74, 0, v28
    v_sub_f32 v75, 0, v28
    v_sub_f32 v104, v104, v28
    v_sub_f32 v105, v105, v28
    v_mfma_f32_16x16x32_bf16 v[136:139], a[240:243], a[144:147], v[72:75]
    v_sub_f32 v106, v106, v28
    v_sub_f32 v107, v107, v28
    v_mfma_f32_16x16x32_bf16 v[136:139], a[244:247], a[148:151], v[136:139]
    v_sub_f32 v108, v108, v28
    v_sub_f32 v109, v109, v28
    v_mfma_f32_16x16x32_bf16 v[136:139], a[248:251], a[152:155], v[136:139]
    v_sub_f32 v110, v110, v28
    v_sub_f32 v111, v111, v28
    v_mfma_f32_16x16x32_bf16 v[140:143], v[52:55], a[144:147], v[72:75]
    v_accvgpr_write_b32 a158, v246
    v_accvgpr_write_b32 a159, v247
    v_mfma_f32_16x16x32_bf16 v[140:143], v[56:59], a[148:151], v[140:143]
    v_accvgpr_write_b32 a160, v248
    v_accvgpr_write_b32 a161, v249
    v_mfma_f32_16x16x32_bf16 v[136:139], a[252:255], a[156:159], v[136:139]
    v_accvgpr_write_b32 a162, v250
    v_accvgpr_write_b32 a163, v251
    s_waitcnt lgkmcnt(0)
    v_mfma_f32_16x16x32_bf16 v[140:143], v[60:63], a[152:155], v[140:143]
    v_accvgpr_write_b32 a164, v252
    v_accvgpr_write_b32 a165, v253
    v_mfma_f32_16x16x32_bf16 v[136:139], v[44:47], a[160:163], v[136:139]
    v_accvgpr_write_b32 a166, v254
    v_accvgpr_write_b32 a167, v255
    v_mfma_f32_16x16x32_bf16 v[140:143], v[64:67], a[156:159], v[140:143]
    v_exp_f32 v104, v104
    v_mfma_f32_16x16x32_bf16 v[136:139], v[48:51], a[164:167], v[136:139]
    v_exp_f32 v105, v105
    v_add_f32 v18, v18, v104
    v_add_f32_e64 v18, v18, v105
    v_cvt_pk_bf16_f32 v104, v104, v105
    v_exp_f32 v106, v106
    v_exp_f32 v107, v107
    v_add_f32 v18, v18, v106
    v_add_f32 v18, v18, v107
    v_cvt_pk_bf16_f32 v105, v106, v107
    v_exp_f32 v108, v108
    v_exp_f32 v109, v109
    v_add_f32 v18, v18, v108
    v_add_f32 v18, v18, v109
    v_cvt_pk_bf16_f32 v106, v108, v109
    v_exp_f32 v110, v110
    v_exp_f32 v111, v111
    v_add_f32 v18, v18, v110
    v_add_f32 v18, v18, v111
    v_cvt_pk_bf16_f32 v107, v110, v111
    v_exp_f32 v96, v96
    v_exp_f32 v97, v97
    v_add_f32 v17, v17, v96
    v_add_f32 v17, v17, v97
    v_cvt_pk_bf16_f32 v96, v96, v97
    v_exp_f32 v98, v98
    v_exp_f32 v99, v99
    v_add_f32 v17, v17, v98
    v_add_f32 v17, v17, v99
    v_cvt_pk_bf16_f32 v97, v98, v99
    v_exp_f32 v100, v100
    v_exp_f32 v101, v101
    v_add_f32 v17, v17, v100
    v_add_f32 v17, v17, v101
    v_cvt_pk_bf16_f32 v98, v100, v101
    v_exp_f32 v102, v102
    v_exp_f32 v103, v103
    v_add_f32 v17, v17, v102
    v_add_f32 v17, v17, v103
    v_cvt_pk_bf16_f32 v99, v102, v103
    ds_read_b128 a[240:243], v2 offset:26624
    ds_read_b128 a[244:247], v2 offset:27136
    ds_read_b64_tr_b16 a[248:249], v3 offset:12288
    ds_read_b64_tr_b16 a[250:251], v4 offset:12288
    ds_read_b64_tr_b16 a[252:253], v5 offset:12288
    ds_read_b64_tr_b16 a[254:255], v6 offset:12288
    ds_read_b64_tr_b16 v[44:45], v3 offset:12800
    ds_read_b64_tr_b16 v[46:47], v4 offset:12800
    ds_read_b64_tr_b16 v[48:49], v5 offset:12800
    ds_read_b64_tr_b16 v[50:51], v6 offset:12800
    ds_read_b64_tr_b16 v[52:53], v3 offset:13312
    ds_read_b64_tr_b16 v[54:55], v4 offset:13312
    ds_read_b64_tr_b16 v[56:57], v5 offset:13312
    ds_read_b64_tr_b16 v[58:59], v6 offset:13312
    ds_read_b64_tr_b16 v[60:61], v3 offset:13824
    s_waitcnt lgkmcnt(11)
    ds_read_b64_tr_b16 v[62:63], v4 offset:13824
    ds_read_b64_tr_b16 v[64:65], v5 offset:13824
    ds_read_b64_tr_b16 v[66:67], v6 offset:13824
    v_exp_f32 v136, v136
    v_exp_f32 v137, v137
    v_add_f32 v18, v18, v136
    v_add_f32_e64 v18, v18, v137
    v_cvt_pk_bf16_f32 v136, v136, v137
    v_exp_f32 v138, v138
    v_exp_f32 v139, v139
    v_add_f32 v18, v18, v138
    v_add_f32 v18, v18, v139
    v_cvt_pk_bf16_f32 v137, v138, v139
    v_mfma_f32_16x16x32_bf16 v[140:143], a[240:243], a[160:163], v[140:143]
    ds_read_b64_tr_b16 a[240:241], v3 offset:14336
    s_waitcnt lgkmcnt(7)
    ds_read_b64_tr_b16 a[242:243], v4 offset:14336
    v_mfma_f32_16x16x32_bf16 v[140:143], a[244:247], a[164:167], v[140:143]
    ds_read_b64_tr_b16 a[244:245], v5 offset:14336
    ds_read_b64_tr_b16 a[246:247], v6 offset:14336
    v_mfma_f32_16x16x32_bf16 v[208:211], a[248:251], v[104:107], 0
    ds_read_b64_tr_b16 a[248:249], v3 offset:14848
    ds_read_b64_tr_b16 a[250:251], v4 offset:14848
    v_mfma_f32_16x16x32_bf16 v[212:215], a[252:255], v[104:107], 0
    ds_read_b64_tr_b16 a[252:253], v5 offset:14848
    ds_read_b64_tr_b16 a[254:255], v6 offset:14848
    v_mfma_f32_16x16x32_bf16 v[216:219], v[44:47], v[104:107], 0
    ds_read_b128 v[44:47], v1 offset:49152
    v_exp_f32 v140, v140
    v_mfma_f32_16x16x32_bf16 v[220:223], v[48:51], v[104:107], 0
    s_waitcnt lgkmcnt(9)
    ds_read_b128 v[48:51], v1 offset:49664
    v_exp_f32 v141, v141
    v_mfma_f32_16x16x32_bf16 v[224:227], v[52:55], v[104:107], 0
    ds_read_b128 v[52:55], v1 offset:50176
    v_add_f32_e64 v18, v18, v140
    v_mfma_f32_16x16x32_bf16 v[228:231], v[56:59], v[104:107], 0
    ds_read_b128 v[56:59], v1 offset:50688
    v_add_f32_e64 v18, v18, v141
    v_mfma_f32_16x16x32_bf16 v[232:235], v[60:63], v[104:107], 0
    ds_read_b128 v[60:63], v1 offset:51200
    v_cvt_pk_bf16_f32 v138, v140, v141
    v_mfma_f32_16x16x32_bf16 v[236:239], v[64:67], v[104:107], 0
    ds_read_b128 v[64:67], v1 offset:51712
    v_exp_f32 v142, v142
    s_waitcnt lgkmcnt(6)
    v_mfma_f32_16x16x32_bf16 v[240:243], a[240:243], v[104:107], 0
    ds_read_b128 a[240:243], v2 offset:49152
    v_exp_f32_e64 v143, v143
    v_mfma_f32_16x16x32_bf16 v[244:247], a[244:247], v[104:107], 0
    ds_read_b128 a[244:247], v2 offset:49664
    v_add_f32_e64 v18, v18, v142
    v_mfma_f32_16x16x32_bf16 v[248:251], a[248:251], v[104:107], 0
    ds_read_b128 a[248:251], v2 offset:50176
    v_add_f32_e64 v18, v18, v143
    v_mfma_f32_16x16x32_bf16 v[252:255], a[252:255], v[104:107], 0
    ds_read_b128 a[252:255], v2 offset:50688
    v_cvt_pk_bf16_f32 v139, v142, v143
    s_waitcnt lgkmcnt(6)
    v_mfma_f32_16x16x32_bf16 v[104:107], v[44:47], a[144:147], v[72:75]
    ds_read_b128 v[44:47], v2 offset:51200
    v_mfma_f32_16x16x32_bf16 v[104:107], v[48:51], a[148:151], v[104:107]
    ds_read_b128 v[48:51], v2 offset:51712
    s_waitcnt vmcnt(3)
    s_add_u32 m0, s40, 98304
    s_mov_b32 s54, 49152
    buffer_load_dwordx4 v11, s[20:23], s54 offen offset:0 nt lds
    v_mfma_f32_16x16x32_bf16 v[104:107], v[52:55], a[152:155], v[104:107]
    ds_read_b64_tr_b16 v[52:53], v3 offset:36864
    ds_read_b64_tr_b16 v[54:55], v4 offset:36864
    v_mfma_f32_16x16x32_bf16 v[104:107], v[56:59], a[156:159], v[104:107]
    ds_read_b64_tr_b16 v[56:57], v5 offset:36864
    ds_read_b64_tr_b16 v[58:59], v6 offset:36864
    s_waitcnt lgkmcnt(7)
    v_mfma_f32_16x16x32_bf16 v[104:107], v[60:63], a[160:163], v[104:107]
    ds_read_b64_tr_b16 v[60:61], v3 offset:37376
    buffer_load_dwordx4 v12, s[20:23], s54 offen offset:1024 nt lds
    ds_read_b64_tr_b16 v[62:63], v4 offset:37376
    v_mfma_f32_16x16x32_bf16 v[104:107], v[64:67], a[164:167], v[104:107]
    ds_read_b64_tr_b16 v[64:65], v5 offset:37376
    ds_read_b64_tr_b16 v[66:67], v6 offset:37376
    v_mfma_f32_16x16x32_bf16 v[108:111], a[240:243], a[144:147], v[72:75]
    ds_read_b64_tr_b16 a[240:241], v3 offset:37888
    ds_read_b64_tr_b16 a[242:243], v4 offset:37888
    v_mfma_f32_16x16x32_bf16 v[108:111], a[244:247], a[148:151], v[108:111]
    buffer_load_dwordx4 v13, s[20:23], s54 offen offset:2048 nt lds
    ds_read_b64_tr_b16 a[244:245], v5 offset:37888
    ds_read_b64_tr_b16 a[246:247], v6 offset:37888
    v_mfma_f32_16x16x32_bf16 v[108:111], a[248:251], a[152:155], v[108:111]
    s_waitcnt lgkmcnt(10)
    ds_read_b64_tr_b16 a[248:249], v3 offset:38400
    ds_read_b64_tr_b16 a[250:251], v4 offset:38400
    v_mfma_f32_16x16x32_bf16 v[108:111], a[252:255], a[156:159], v[108:111]
    ds_read_b64_tr_b16 a[252:253], v5 offset:38400
    ds_read_b64_tr_b16 a[254:255], v6 offset:38400
    v_mfma_f32_16x16x32_bf16 v[108:111], v[44:47], a[160:163], v[108:111]
    ds_read_b64_tr_b16 v[44:45], v3 offset:38912
    s_waitcnt lgkmcnt(11)
    ds_read_b64_tr_b16 v[46:47], v4 offset:38912
    v_mfma_f32_16x16x32_bf16 v[108:111], v[48:51], a[164:167], v[108:111]
    ds_read_b64_tr_b16 v[48:49], v5 offset:38912
    ds_read_b64_tr_b16 v[50:51], v6 offset:38912
    v_mfma_f32_16x16x32_bf16 v[208:211], v[52:55], v[136:139], v[208:211]
    ds_read_b64_tr_b16 v[52:53], v3 offset:39424
    s_waitcnt lgkmcnt(11)
    ds_read_b64_tr_b16 v[54:55], v4 offset:39424
    v_mfma_f32_16x16x32_bf16 v[212:215], v[56:59], v[136:139], v[212:215]
    ds_read_b64_tr_b16 v[56:57], v5 offset:39424
    ds_read_b64_tr_b16 v[58:59], v6 offset:39424
    v_mfma_f32_16x16x32_bf16 v[216:219], v[60:63], v[136:139], v[216:219]
    v_exp_f32_e64 v104, v104
    v_mfma_f32_16x16x32_bf16 v[220:223], v[64:67], v[136:139], v[220:223]
    v_exp_f32_e64 v105, v105
    v_mfma_f32_16x16x32_bf16 v[224:227], a[240:243], v[136:139], v[224:227]
    v_add_f32_e64 v18, v18, v104
    v_add_f32 v18, v18, v105
    s_waitcnt lgkmcnt(7)
    v_mfma_f32_16x16x32_bf16 v[228:231], a[244:247], v[136:139], v[228:231]
    v_cvt_pk_bf16_f32 v104, v104, v105
    v_exp_f32_e64 v106, v106
    v_mfma_f32_16x16x32_bf16 v[232:235], a[248:251], v[136:139], v[232:235]
    v_exp_f32_e64 v107, v107
    v_mfma_f32_16x16x32_bf16 v[236:239], a[252:255], v[136:139], v[236:239]
    v_add_f32_e64 v18, v18, v106
    v_add_f32 v18, v18, v107
    s_waitcnt lgkmcnt(2)
    v_mfma_f32_16x16x32_bf16 v[240:243], v[44:47], v[136:139], v[240:243]
    v_cvt_pk_bf16_f32 v105, v106, v107
    v_exp_f32_e64 v108, v108
    v_mfma_f32_16x16x32_bf16 v[244:247], v[48:51], v[136:139], v[244:247]
    v_exp_f32_e64 v109, v109
    v_mfma_f32_16x16x32_bf16 v[248:251], v[52:55], v[136:139], v[248:251]
    v_add_f32_e64 v18, v18, v108
    v_add_f32 v18, v18, v109
    s_waitcnt lgkmcnt(0)
    v_mfma_f32_16x16x32_bf16 v[252:255], v[56:59], v[136:139], v[252:255]
    v_cvt_pk_bf16_f32 v106, v108, v109
    s_waitcnt vmcnt(3)
    s_add_u32 m0, s40, 110592
    s_mov_b32 s54, 49152
    buffer_load_dwordx4 v14, s[24:27], s54 offen offset:0 nt lds
    buffer_load_dwordx4 v15, s[24:27], s54 offen offset:1024 nt lds
    buffer_load_dwordx4 v16, s[24:27], s54 offen offset:2048 nt lds
    s_mov_b32 s46, 61440
    s_mov_b32 s36, 49152
    s_mov_b32 s37, 98304
    s_mov_b32 s38, 0
    v_add_u32 v1, 49152, v7
    v_add_u32 v2, 49152, v8
    s_waitcnt vmcnt(9) lgkmcnt(0)
    s_barrier
    ds_read_b128 v[44:47], v1 offset:24576
    ds_read_b128 v[48:51], v1 offset:25088
    ds_read_b128 v[52:55], v1 offset:25600
    ds_read_b128 v[56:59], v1 offset:26112
    ds_read_b128 v[60:63], v1 offset:26624
.p2align 6
    s_nop 0
    s_nop 0
    s_nop 0
    s_nop 0
L_peel:
L_loop:
    s_waitcnt lgkmcnt(3)
    v_mfma_f32_16x16x32_bf16 v[128:131], v[44:47], a[120:123], v[68:71]
    v_add_u32 v3, s36, v9
    v_add_u32_e64 v4, s36, v10
    v_mfma_f32_16x16x32_bf16 v[136:139], v[44:47], a[144:147], v[72:75]
    v_xor_b32 v5, 32, v3
    v_xor_b32 v6, 32, v4
    v_mfma_f32_16x16x32_bf16 v[144:147], v[44:47], a[168:171], v[76:79]
    ds_read_b128 v[64:67], v1 offset:27136
    ds_read_b64 v[90:91], v23 offset:0
    v_mfma_f32_16x16x32_bf16 v[152:155], v[44:47], a[192:195], v[80:83]
    v_exp_f32_e64 v110, v110
    v_mfma_f32_16x16x32_bf16 v[92:95], v[44:47], a[216:219], v[84:87]
    ds_read_b128 v[44:47], v2 offset:24576
    v_add_f32_e64 v18, v18, v110
    v_mfma_f32_16x16x32_bf16 v[128:131], v[48:51], a[124:127], v[128:131]
    v_exp_f32_e64 v111, v111
    v_mfma_f32_16x16x32_bf16 v[136:139], v[48:51], a[148:151], v[136:139]
    v_cvt_pk_bf16_f32 v107, v110, v111
    v_add_f32_e64 v18, v18, v111
    v_mfma_f32_16x16x32_bf16 v[144:147], v[48:51], a[172:175], v[144:147]
    v_exp_f32_e64 v112, v112
    v_mfma_f32_16x16x32_bf16 v[152:155], v[48:51], a[196:199], v[152:155]
    v_exp_f32_e64 v113, v113
    v_mfma_f32_16x16x32_bf16 v[92:95], v[48:51], a[220:223], v[92:95]
    ds_read_b128 v[48:51], v2 offset:25088
    s_waitcnt lgkmcnt(5)
    v_mfma_f32_16x16x32_bf16 v[128:131], v[52:55], a[128:131], v[128:131]
    v_add_f32 v19, v19, v112
    v_add_f32_e64 v19, v19, v113
    v_mfma_f32_16x16x32_bf16 v[136:139], v[52:55], a[152:155], v[136:139]
    v_cvt_pk_bf16_f32 v112, v112, v113
    v_mfma_f32_16x16x32_bf16 v[144:147], v[52:55], a[176:179], v[144:147]
    v_exp_f32_e64 v114, v114
    v_mfma_f32_16x16x32_bf16 v[152:155], v[52:55], a[200:203], v[152:155]
    v_exp_f32_e64 v115, v115
    v_mfma_f32_16x16x32_bf16 v[92:95], v[52:55], a[224:227], v[92:95]
    ds_read_b128 v[52:55], v2 offset:25600
    v_add_f32_e64 v19, v19, v114
    v_mfma_f32_16x16x32_bf16 v[128:131], v[56:59], a[132:135], v[128:131]
    v_add_f32_e64 v19, v19, v115
    v_cvt_pk_bf16_f32 v113, v114, v115
    v_mfma_f32_16x16x32_bf16 v[136:139], v[56:59], a[156:159], v[136:139]
    v_exp_f32_e64 v116, v116
    v_mfma_f32_16x16x32_bf16 v[144:147], v[56:59], a[180:183], v[144:147]
    v_exp_f32_e64 v117, v117
    v_mfma_f32_16x16x32_bf16 v[152:155], v[56:59], a[204:207], v[152:155]
    v_cvt_pk_bf16_f32 v114, v116, v117
    v_add_f32_e64 v19, v19, v116
    v_mfma_f32_16x16x32_bf16 v[92:95], v[56:59], a[228:231], v[92:95]
    ds_read_b128 v[56:59], v2 offset:26112
    s_waitcnt lgkmcnt(5)
    v_mfma_f32_16x16x32_bf16 v[128:131], v[60:63], a[136:139], v[128:131]
    v_exp_f32 v118, v118
    v_mfma_f32_16x16x32_bf16 v[136:139], v[60:63], a[160:163], v[136:139]
    v_exp_f32_e64 v119, v119
    v_mfma_f32_16x16x32_bf16 v[144:147], v[60:63], a[184:187], v[144:147]
    v_cvt_pk_bf16_f32 v115, v118, v119
    v_add_f32_e64 v19, v19, v117
    v_mfma_f32_16x16x32_bf16 v[152:155], v[60:63], a[208:211], v[152:155]
    v_exp_f32_e64 v120, v120
    v_mfma_f32_16x16x32_bf16 v[92:95], v[60:63], a[232:235], v[92:95]
    ds_read_b128 v[60:63], v2 offset:26624
    v_add_f32_e64 v20, v20, v120
    v_mfma_f32_16x16x32_bf16 v[128:131], v[64:67], a[140:143], v[128:131]
    v_exp_f32_e64 v121, v121
    v_mfma_f32_16x16x32_bf16 v[136:139], v[64:67], a[164:167], v[136:139]
    v_add_f32_e64 v20, v20, v121
    v_cvt_pk_bf16_f32 v120, v120, v121
    v_mfma_f32_16x16x32_bf16 v[144:147], v[64:67], a[188:191], v[144:147]
    v_exp_f32_e64 v122, v122
    v_mfma_f32_16x16x32_bf16 v[152:155], v[64:67], a[212:215], v[152:155]
    v_exp_f32_e64 v123, v123
    v_mfma_f32_16x16x32_bf16 v[92:95], v[64:67], a[236:239], v[92:95]
    ds_read_b128 v[64:67], v2 offset:27136
    s_waitcnt lgkmcnt(4)
    v_mfma_f32_16x16x32_bf16 v[132:135], v[44:47], a[120:123], v[68:71]
    v_add_f32 v20, v20, v122
    v_add_f32_e64 v20, v20, v123
    v_mfma_f32_16x16x32_bf16 v[140:143], v[44:47], a[144:147], v[72:75]
    v_cvt_pk_bf16_f32 v121, v122, v123
    v_add_f32_e64 v19, v19, v118
    v_mfma_f32_16x16x32_bf16 v[148:151], v[44:47], a[168:171], v[76:79]
    v_exp_f32_e64 v124, v124
    v_mfma_f32_16x16x32_bf16 v[156:159], v[44:47], a[192:195], v[80:83]
    ds_read_b64_tr_b16 v[44:45], v3 offset:12288
    ds_read_b64_tr_b16 v[46:47], v4 offset:12288
    v_mfma_f32_16x16x32_bf16 v[132:135], v[48:51], a[124:127], v[132:135]
    v_exp_f32_e64 v125, v125
    v_mfma_f32_16x16x32_bf16 v[140:143], v[48:51], a[148:151], v[140:143]
    v_cvt_pk_bf16_f32 v122, v124, v125
    v_add_f32_e64 v19, v19, v119
    v_mfma_f32_16x16x32_bf16 v[148:151], v[48:51], a[172:175], v[148:151]
    v_exp_f32_e64 v126, v126
    v_mfma_f32_16x16x32_bf16 v[156:159], v[48:51], a[196:199], v[156:159]
    ds_read_b64_tr_b16 v[48:49], v5 offset:12288
    s_waitcnt lgkmcnt(5)
    v_mfma_f32_16x16x32_bf16 v[132:135], v[52:55], a[128:131], v[132:135]
    ds_read_b64_tr_b16 v[50:51], v6 offset:12288
    v_add_f32 v20, v20, v124
    v_mfma_f32_16x16x32_bf16 v[140:143], v[52:55], a[152:155], v[140:143]
    v_exp_f32_e64 v127, v127
    v_mfma_f32_16x16x32_bf16 v[148:151], v[52:55], a[176:179], v[148:151]
    v_cvt_pk_bf16_f32 v123, v126, v127
    v_add_f32_e64 v20, v20, v125
    v_mfma_f32_16x16x32_bf16 v[156:159], v[52:55], a[200:203], v[156:159]
    ds_read_b64_tr_b16 v[52:53], v3 offset:12800
    ds_read_b64_tr_b16 v[54:55], v4 offset:12800
    v_mfma_f32_16x16x32_bf16 v[132:135], v[56:59], a[132:135], v[132:135]
    v_exp_f32_e64 v92, v92
    v_mfma_f32_16x16x32_bf16 v[140:143], v[56:59], a[156:159], v[140:143]
    v_exp_f32_e64 v93, v93
    v_mfma_f32_16x16x32_bf16 v[148:151], v[56:59], a[180:183], v[148:151]
    v_add_f32 v21, v21, v92
    v_add_f32 v21, v21, v93
    v_mfma_f32_16x16x32_bf16 v[156:159], v[56:59], a[204:207], v[156:159]
    s_add_u32 m0, s37, s42
    s_waitcnt lgkmcnt(6)
    v_mfma_f32_16x16x32_bf16 v[132:135], v[60:63], a[136:139], v[132:135]
    buffer_load_dwordx4 v11, s[20:23], s46 offen offset:0 nt lds
    v_mfma_f32_16x16x32_bf16 v[140:143], v[60:63], a[160:163], v[140:143]
    ds_read_b64_tr_b16 v[56:57], v5 offset:12800
    ds_read_b64_tr_b16 v[58:59], v6 offset:12800
    v_mfma_f32_16x16x32_bf16 v[148:151], v[60:63], a[184:187], v[148:151]
    v_cvt_pk_bf16_f32 v92, v92, v93
    v_add_f32_e64 v20, v20, v126
    v_mfma_f32_16x16x32_bf16 v[156:159], v[60:63], a[208:211], v[156:159]
    ds_read_b64_tr_b16 v[60:61], v3 offset:13312
    ds_read_b64_tr_b16 v[62:63], v4 offset:13312
    v_mfma_f32_16x16x32_bf16 v[132:135], v[64:67], a[140:143], v[132:135]
    v_exp_f32_e64 v94, v94
    v_mfma_f32_16x16x32_bf16 v[140:143], v[64:67], a[164:167], v[140:143]
    buffer_load_dwordx4 v12, s[20:23], s46 offen offset:1024 nt lds
    v_mfma_f32_16x16x32_bf16 v[148:151], v[64:67], a[188:191], v[148:151]
    v_exp_f32_e64 v95, v95
    v_mfma_f32_16x16x32_bf16 v[156:159], v[64:67], a[212:215], v[156:159]
    ds_read_b64_tr_b16 v[64:65], v5 offset:13312
    s_waitcnt lgkmcnt(7)
    v_mfma_f32_16x16x32_bf16 v[160:163], v[44:47], v[96:99], v[160:163]
    v_add_u32 v1, s37, v7
    v_add_u32_e64 v2, s37, v8
    v_mfma_f32_16x16x32_bf16 v[208:211], v[44:47], v[104:107], v[208:211]
    ds_read_b64_tr_b16 v[66:67], v6 offset:13312
    v_cvt_pk_bf16_f32 v93, v94, v95
    v_mfma_f32_16x16x32_bf16 a[0:3], v[44:47], v[112:115], a[0:3]
    ds_write_b64 v22, v[92:93] offset:2048
    v_mfma_f32_16x16x32_bf16 a[48:51], v[44:47], v[120:123], a[48:51]
    buffer_load_dwordx4 v13, s[20:23], s46 offen offset:2048 nt lds
    v_mfma_f32_16x16x32_bf16 a[96:99], v[44:47], v[88:91], a[96:99]
    ds_read_b64_tr_b16 v[44:45], v3 offset:13824
    ds_read_b64_tr_b16 v[46:47], v4 offset:13824
    v_mfma_f32_16x16x32_bf16 v[164:167], v[48:51], v[96:99], v[164:167]
    v_add_f32 v20, v20, v127
    v_add_f32 v21, v21, v94
    v_mfma_f32_16x16x32_bf16 v[212:215], v[48:51], v[104:107], v[212:215]
    v_add_f32_e64 v21, v21, v95
    v_mfma_f32_16x16x32_bf16 a[4:7], v[48:51], v[112:115], a[4:7]
    s_add_u32 m0, s37, s43
    v_mfma_f32_16x16x32_bf16 a[52:55], v[48:51], v[120:123], a[52:55]
    buffer_load_dwordx4 v14, s[24:27], s46 offen offset:0 nt lds
    s_waitcnt lgkmcnt(7)
    v_mfma_f32_16x16x32_bf16 v[168:171], v[52:55], v[96:99], v[168:171]
    ds_read_b64_tr_b16 v[48:49], v5 offset:13824
    ds_read_b64_tr_b16 v[50:51], v6 offset:13824
    v_mfma_f32_16x16x32_bf16 v[216:219], v[52:55], v[104:107], v[216:219]
    v_exp_f32_e64 v128, v128
    v_mfma_f32_16x16x32_bf16 a[8:11], v[52:55], v[112:115], a[8:11]
    v_exp_f32_e64 v129, v129
    v_mfma_f32_16x16x32_bf16 a[56:59], v[52:55], v[120:123], a[56:59]
    v_add_f32 v17, v17, v128
    v_add_f32 v17, v17, v129
    v_mfma_f32_16x16x32_bf16 a[100:103], v[52:55], v[88:91], a[100:103]
    buffer_load_dwordx4 v15, s[24:27], s46 offen offset:1024 nt lds
    v_mfma_f32_16x16x32_bf16 v[172:175], v[56:59], v[96:99], v[172:175]
    ds_read_b64_tr_b16 v[52:53], v3 offset:14336
    ds_read_b64_tr_b16 v[54:55], v4 offset:14336
    v_mfma_f32_16x16x32_bf16 v[220:223], v[56:59], v[104:107], v[220:223]
    v_cvt_pk_bf16_f32 v128, v128, v129
    v_mfma_f32_16x16x32_bf16 a[12:15], v[56:59], v[112:115], a[12:15]
    v_exp_f32_e64 v130, v130
    v_mfma_f32_16x16x32_bf16 a[60:63], v[56:59], v[120:123], a[60:63]
    ds_read_b64_tr_b16 v[56:57], v5 offset:14336
    s_waitcnt lgkmcnt(8)
    v_mfma_f32_16x16x32_bf16 v[176:179], v[60:63], v[96:99], v[176:179]
    buffer_load_dwordx4 v16, s[24:27], s46 offen offset:2048 nt lds
    v_mfma_f32_16x16x32_bf16 v[224:227], v[60:63], v[104:107], v[224:227]
    s_add_u32 s46, s46, 12288
    ds_read_b64_tr_b16 v[58:59], v6 offset:14336
    v_mfma_f32_16x16x32_bf16 a[16:19], v[60:63], v[112:115], a[16:19]
    v_exp_f32 v131, v131
    v_mfma_f32_16x16x32_bf16 a[64:67], v[60:63], v[120:123], a[64:67]
    v_add_f32 v17, v17, v130
    v_add_f32 v17, v17, v131
    v_mfma_f32_16x16x32_bf16 a[104:107], v[60:63], v[88:91], a[104:107]
    ds_read_b64_tr_b16 v[60:61], v3 offset:14848
    ds_read_b64_tr_b16 v[62:63], v4 offset:14848
    v_mfma_f32_16x16x32_bf16 v[180:183], v[64:67], v[96:99], v[180:183]
    v_cvt_pk_bf16_f32 v129, v130, v131
    v_mfma_f32_16x16x32_bf16 v[228:231], v[64:67], v[104:107], v[228:231]
    v_exp_f32_e64 v132, v132
    v_mfma_f32_16x16x32_bf16 a[20:23], v[64:67], v[112:115], a[20:23]
    v_exp_f32_e64 v133, v133
    v_mfma_f32_16x16x32_bf16 a[68:71], v[64:67], v[120:123], a[68:71]
    ds_read_b64_tr_b16 v[64:65], v5 offset:14848
    s_waitcnt lgkmcnt(7)
    v_mfma_f32_16x16x32_bf16 v[184:187], v[44:47], v[96:99], v[184:187]
    ds_read_b64_tr_b16 v[66:67], v6 offset:14848
    v_add_f32 v17, v17, v132
    v_mfma_f32_16x16x32_bf16 v[232:235], v[44:47], v[104:107], v[232:235]
    v_add_f32_e64 v17, v17, v133
    v_cvt_pk_bf16_f32 v130, v132, v133
    v_mfma_f32_16x16x32_bf16 a[24:27], v[44:47], v[112:115], a[24:27]
    s_waitcnt vmcnt(9)
    s_barrier
    v_mfma_f32_16x16x32_bf16 a[72:75], v[44:47], v[120:123], a[72:75]
    v_exp_f32_e64 v134, v134
    v_mfma_f32_16x16x32_bf16 a[108:111], v[44:47], v[88:91], a[108:111]
    ds_read_b128 v[44:47], v1 offset:0
    v_add_f32_e64 v17, v17, v134
    v_mfma_f32_16x16x32_bf16 v[188:191], v[48:51], v[96:99], v[188:191]
    v_exp_f32_e64 v135, v135
    v_mfma_f32_16x16x32_bf16 v[236:239], v[48:51], v[104:107], v[236:239]
    v_add_f32_e64 v17, v17, v135
    v_cvt_pk_bf16_f32 v131, v134, v135
    v_mfma_f32_16x16x32_bf16 a[28:31], v[48:51], v[112:115], a[28:31]
    v_exp_f32_e64 v136, v136
    v_mfma_f32_16x16x32_bf16 a[76:79], v[48:51], v[120:123], a[76:79]
    ds_read_b128 v[48:51], v1 offset:512
    s_waitcnt lgkmcnt(6)
    v_mfma_f32_16x16x32_bf16 v[192:195], v[52:55], v[96:99], v[192:195]
    v_exp_f32 v137, v137
    v_mfma_f32_16x16x32_bf16 v[240:243], v[52:55], v[104:107], v[240:243]
    v_add_f32 v18, v18, v136
    v_add_f32 v18, v18, v137
    v_mfma_f32_16x16x32_bf16 a[32:35], v[52:55], v[112:115], a[32:35]
    v_cvt_pk_bf16_f32 v136, v136, v137
    v_mfma_f32_16x16x32_bf16 a[80:83], v[52:55], v[120:123], a[80:83]
    v_exp_f32_e64 v138, v138
    v_mfma_f32_16x16x32_bf16 a[112:115], v[52:55], v[88:91], a[112:115]
    ds_read_b128 v[52:55], v1 offset:1024
    v_add_f32_e64 v18, v18, v138
    v_mfma_f32_16x16x32_bf16 v[196:199], v[56:59], v[96:99], v[196:199]
    v_exp_f32_e64 v139, v139
    v_mfma_f32_16x16x32_bf16 v[244:247], v[56:59], v[104:107], v[244:247]
    v_add_f32_e64 v18, v18, v139
    v_cvt_pk_bf16_f32 v137, v138, v139
    v_mfma_f32_16x16x32_bf16 a[36:39], v[56:59], v[112:115], a[36:39]
    v_exp_f32_e64 v140, v140
    v_mfma_f32_16x16x32_bf16 a[84:87], v[56:59], v[120:123], a[84:87]
    ds_read_b128 v[56:59], v1 offset:1536
    s_waitcnt lgkmcnt(4)
    v_mfma_f32_16x16x32_bf16 v[200:203], v[60:63], v[96:99], v[200:203]
    v_exp_f32 v141, v141
    v_mfma_f32_16x16x32_bf16 v[248:251], v[60:63], v[104:107], v[248:251]
    v_add_f32 v18, v18, v140
    v_add_f32 v18, v18, v141
    v_mfma_f32_16x16x32_bf16 a[40:43], v[60:63], v[112:115], a[40:43]
    v_cvt_pk_bf16_f32 v138, v140, v141
    v_mfma_f32_16x16x32_bf16 a[88:91], v[60:63], v[120:123], a[88:91]
    v_mfma_f32_16x16x32_bf16 a[116:119], v[60:63], v[88:91], a[116:119]
    ds_read_b128 v[60:63], v1 offset:2048
    v_mfma_f32_16x16x32_bf16 v[204:207], v[64:67], v[96:99], v[204:207]
    v_mfma_f32_16x16x32_bf16 v[252:255], v[64:67], v[104:107], v[252:255]
    v_mfma_f32_16x16x32_bf16 a[44:47], v[64:67], v[112:115], a[44:47]
    s_cmp_eq_u32 s46, 196608
    v_mfma_f32_16x16x32_bf16 a[92:95], v[64:67], v[120:123], a[92:95]
    s_cbranch_scc1 L_tail
L_h1:
    s_waitcnt lgkmcnt(3)
    v_mfma_f32_16x16x32_bf16 v[96:99], v[44:47], a[120:123], v[68:71]
    ds_read_b128 v[64:67], v1 offset:2560
    ds_read_b64 v[94:95], v23 offset:2048
    v_mfma_f32_16x16x32_bf16 v[104:107], v[44:47], a[144:147], v[72:75]
    v_exp_f32_e64 v142, v142
    v_mfma_f32_16x16x32_bf16 v[112:115], v[44:47], a[168:171], v[76:79]
    v_exp_f32_e64 v143, v143
    v_mfma_f32_16x16x32_bf16 v[120:123], v[44:47], a[192:195], v[80:83]
    v_cvt_pk_bf16_f32 v139, v142, v143
    v_add_f32_e64 v18, v18, v142
    v_mfma_f32_16x16x32_bf16 v[88:91], v[44:47], a[216:219], v[84:87]
    ds_read_b128 v[44:47], v2 offset:0
    v_add_f32_e64 v18, v18, v143
    v_mfma_f32_16x16x32_bf16 v[96:99], v[48:51], a[124:127], v[96:99]
    v_exp_f32_e64 v144, v144
    v_mfma_f32_16x16x32_bf16 v[104:107], v[48:51], a[148:151], v[104:107]
    v_exp_f32_e64 v145, v145
    v_mfma_f32_16x16x32_bf16 v[112:115], v[48:51], a[172:175], v[112:115]
    v_add_f32 v19, v19, v144
    v_add_f32 v19, v19, v145
    v_mfma_f32_16x16x32_bf16 v[120:123], v[48:51], a[196:199], v[120:123]
    v_cvt_pk_bf16_f32 v144, v144, v145
    v_mfma_f32_16x16x32_bf16 v[88:91], v[48:51], a[220:223], v[88:91]
    ds_read_b128 v[48:51], v2 offset:512
    s_waitcnt lgkmcnt(5)
    v_mfma_f32_16x16x32_bf16 v[96:99], v[52:55], a[128:131], v[96:99]
    v_exp_f32 v146, v146
    v_mfma_f32_16x16x32_bf16 v[104:107], v[52:55], a[152:155], v[104:107]
    v_exp_f32_e64 v147, v147
    v_mfma_f32_16x16x32_bf16 v[112:115], v[52:55], a[176:179], v[112:115]
    v_add_f32 v19, v19, v146
    v_add_f32 v19, v19, v147
    v_mfma_f32_16x16x32_bf16 v[120:123], v[52:55], a[200:203], v[120:123]
    v_cvt_pk_bf16_f32 v145, v146, v147
    v_mfma_f32_16x16x32_bf16 v[88:91], v[52:55], a[224:227], v[88:91]
    v_exp_f32_e64 v148, v148
    v_mfma_f32_16x16x32_bf16 v[96:99], v[56:59], a[132:135], v[96:99]
    ds_read_b128 v[52:55], v2 offset:1024
    v_add_f32_e64 v19, v19, v148
    v_mfma_f32_16x16x32_bf16 v[104:107], v[56:59], a[156:159], v[104:107]
    v_exp_f32_e64 v149, v149
    v_mfma_f32_16x16x32_bf16 v[112:115], v[56:59], a[180:183], v[112:115]
    v_cvt_pk_bf16_f32 v146, v148, v149
    v_add_f32_e64 v19, v19, v149
    v_mfma_f32_16x16x32_bf16 v[120:123], v[56:59], a[204:207], v[120:123]
    v_exp_f32_e64 v150, v150
    v_mfma_f32_16x16x32_bf16 v[88:91], v[56:59], a[228:231], v[88:91]
    ds_read_b128 v[56:59], v2 offset:1536
    s_waitcnt lgkmcnt(5)
    v_mfma_f32_16x16x32_bf16 v[96:99], v[60:63], a[136:139], v[96:99]
    v_exp_f32 v151, v151
    v_mfma_f32_16x16x32_bf16 v[104:107], v[60:63], a[160:163], v[104:107]
    v_cvt_pk_bf16_f32 v147, v150, v151
    v_add_f32_e64 v19, v19, v150
    v_mfma_f32_16x16x32_bf16 v[112:115], v[60:63], a[184:187], v[112:115]
    v_exp_f32_e64 v152, v152
    v_mfma_f32_16x16x32_bf16 v[120:123], v[60:63], a[208:211], v[120:123]
    v_exp_f32_e64 v153, v153
    v_mfma_f32_16x16x32_bf16 v[88:91], v[60:63], a[232:235], v[88:91]
    ds_read_b128 v[60:63], v2 offset:2048
    v_add_f32_e64 v20, v20, v152
    v_mfma_f32_16x16x32_bf16 v[96:99], v[64:67], a[140:143], v[96:99]
    v_add_f32_e64 v20, v20, v153
    v_cvt_pk_bf16_f32 v152, v152, v153
    v_mfma_f32_16x16x32_bf16 v[104:107], v[64:67], a[164:167], v[104:107]
    v_exp_f32_e64 v154, v154
    v_mfma_f32_16x16x32_bf16 v[112:115], v[64:67], a[188:191], v[112:115]
    v_exp_f32_e64 v155, v155
    v_mfma_f32_16x16x32_bf16 v[120:123], v[64:67], a[212:215], v[120:123]
    v_add_f32 v20, v20, v154
    v_add_f32 v20, v20, v155
    v_mfma_f32_16x16x32_bf16 v[88:91], v[64:67], a[236:239], v[88:91]
    ds_read_b128 v[64:67], v2 offset:2560
    s_waitcnt lgkmcnt(4)
    v_mfma_f32_16x16x32_bf16 v[100:103], v[44:47], a[120:123], v[68:71]
    v_cvt_pk_bf16_f32 v153, v154, v155
    v_add_f32 v19, v19, v151
    v_mfma_f32_16x16x32_bf16 v[108:111], v[44:47], a[144:147], v[72:75]
    v_exp_f32_e64 v156, v156
    v_mfma_f32_16x16x32_bf16 v[116:119], v[44:47], a[168:171], v[76:79]
    v_exp_f32_e64 v157, v157
    v_mfma_f32_16x16x32_bf16 v[124:127], v[44:47], a[192:195], v[80:83]
    ds_read_b64_tr_b16 v[44:45], v3 offset:36864
    ds_read_b64_tr_b16 v[46:47], v4 offset:36864
    v_mfma_f32_16x16x32_bf16 v[100:103], v[48:51], a[124:127], v[100:103]
    v_cvt_pk_bf16_f32 v154, v156, v157
    v_add_f32_e64 v20, v20, v156
    v_mfma_f32_16x16x32_bf16 v[108:111], v[48:51], a[148:151], v[108:111]
    v_exp_f32_e64 v158, v158
    v_mfma_f32_16x16x32_bf16 v[116:119], v[48:51], a[172:175], v[116:119]
    v_exp_f32_e64 v159, v159
    v_mfma_f32_16x16x32_bf16 v[124:127], v[48:51], a[196:199], v[124:127]
    ds_read_b64_tr_b16 v[48:49], v5 offset:36864
    s_waitcnt lgkmcnt(5)
    v_mfma_f32_16x16x32_bf16 v[100:103], v[52:55], a[128:131], v[100:103]
    ds_read_b64_tr_b16 v[50:51], v6 offset:36864
    v_cvt_pk_bf16_f32 v155, v158, v159
    v_mfma_f32_16x16x32_bf16 v[108:111], v[52:55], a[152:155], v[108:111]
    v_exp_f32 v88, v88
    v_mfma_f32_16x16x32_bf16 v[116:119], v[52:55], a[176:179], v[116:119]
    v_exp_f32_e64 v89, v89
    v_mfma_f32_16x16x32_bf16 v[124:127], v[52:55], a[200:203], v[124:127]
    ds_read_b64_tr_b16 v[52:53], v3 offset:37376
    ds_read_b64_tr_b16 v[54:55], v4 offset:37376
    v_mfma_f32_16x16x32_bf16 v[100:103], v[56:59], a[132:135], v[100:103]
    v_add_f32 v21, v21, v88
    v_add_f32 v21, v21, v89
    v_mfma_f32_16x16x32_bf16 v[108:111], v[56:59], a[156:159], v[108:111]
    v_cvt_pk_bf16_f32 v88, v88, v89
    v_add_f32_e64 v20, v20, v157
    v_mfma_f32_16x16x32_bf16 v[116:119], v[56:59], a[180:183], v[116:119]
    v_exp_f32_e64 v90, v90
    v_mfma_f32_16x16x32_bf16 v[124:127], v[56:59], a[204:207], v[124:127]
    s_add_u32 m0, s38, s40
    s_waitcnt lgkmcnt(6)
    v_mfma_f32_16x16x32_bf16 v[100:103], v[60:63], a[136:139], v[100:103]
    buffer_load_dwordx4 v11, s[20:23], s46 offen offset:0 nt lds
    v_mfma_f32_16x16x32_bf16 v[108:111], v[60:63], a[160:163], v[108:111]
    ds_read_b64_tr_b16 v[56:57], v5 offset:37376
    ds_read_b64_tr_b16 v[58:59], v6 offset:37376
    v_mfma_f32_16x16x32_bf16 v[116:119], v[60:63], a[184:187], v[116:119]
    v_exp_f32_e64 v91, v91
    v_mfma_f32_16x16x32_bf16 v[124:127], v[60:63], a[208:211], v[124:127]
    ds_read_b64_tr_b16 v[60:61], v3 offset:37888
    ds_read_b64_tr_b16 v[62:63], v4 offset:37888
    v_mfma_f32_16x16x32_bf16 v[100:103], v[64:67], a[140:143], v[100:103]
    v_cvt_pk_bf16_f32 v89, v90, v91
    v_add_f32_e64 v20, v20, v158
    v_mfma_f32_16x16x32_bf16 v[108:111], v[64:67], a[164:167], v[108:111]
    buffer_load_dwordx4 v12, s[20:23], s46 offen offset:1024 nt lds
    v_mfma_f32_16x16x32_bf16 v[116:119], v[64:67], a[188:191], v[116:119]
    ds_write_b64 v22, v[88:89] offset:0
    v_mfma_f32_16x16x32_bf16 v[124:127], v[64:67], a[212:215], v[124:127]
    ds_read_b64_tr_b16 v[64:65], v5 offset:37888
    s_waitcnt lgkmcnt(8)
    v_mfma_f32_16x16x32_bf16 v[160:163], v[44:47], v[128:131], v[160:163]
    ds_read_b64_tr_b16 v[66:67], v6 offset:37888
    v_add_f32 v20, v20, v159
    v_mfma_f32_16x16x32_bf16 v[208:211], v[44:47], v[136:139], v[208:211]
    v_add_f32 v21, v21, v90
    v_add_f32 v21, v21, v91
    v_mfma_f32_16x16x32_bf16 a[0:3], v[44:47], v[144:147], a[0:3]
    v_exp_f32_e64 v96, v96
    v_mfma_f32_16x16x32_bf16 a[48:51], v[44:47], v[152:155], a[48:51]
    buffer_load_dwordx4 v13, s[20:23], s46 offen offset:2048 nt lds
    v_mfma_f32_16x16x32_bf16 a[96:99], v[44:47], v[92:95], a[96:99]
    ds_read_b64_tr_b16 v[44:45], v3 offset:38400
    ds_read_b64_tr_b16 v[46:47], v4 offset:38400
    v_mfma_f32_16x16x32_bf16 v[164:167], v[48:51], v[128:131], v[164:167]
    v_exp_f32_e64 v97, v97
    v_mfma_f32_16x16x32_bf16 v[212:215], v[48:51], v[136:139], v[212:215]
    v_add_f32 v17, v17, v96
    v_add_f32 v17, v17, v97
    v_mfma_f32_16x16x32_bf16 a[4:7], v[48:51], v[144:147], a[4:7]
    s_add_u32 m0, s38, s41
    v_cvt_pk_bf16_f32 v96, v96, v97
    v_mfma_f32_16x16x32_bf16 a[52:55], v[48:51], v[152:155], a[52:55]
    buffer_load_dwordx4 v14, s[24:27], s46 offen offset:0 nt lds
    s_waitcnt lgkmcnt(7)
    v_mfma_f32_16x16x32_bf16 v[168:171], v[52:55], v[128:131], v[168:171]
    ds_read_b64_tr_b16 v[48:49], v5 offset:38400
    ds_read_b64_tr_b16 v[50:51], v6 offset:38400
    v_mfma_f32_16x16x32_bf16 v[216:219], v[52:55], v[136:139], v[216:219]
    v_exp_f32_e64 v98, v98
    v_mfma_f32_16x16x32_bf16 a[8:11], v[52:55], v[144:147], a[8:11]
    v_exp_f32_e64 v99, v99
    v_mfma_f32_16x16x32_bf16 a[56:59], v[52:55], v[152:155], a[56:59]
    v_add_f32 v17, v17, v98
    v_add_f32 v17, v17, v99
    v_mfma_f32_16x16x32_bf16 a[100:103], v[52:55], v[92:95], a[100:103]
    buffer_load_dwordx4 v15, s[24:27], s46 offen offset:1024 nt lds
    v_mfma_f32_16x16x32_bf16 v[172:175], v[56:59], v[128:131], v[172:175]
    ds_read_b64_tr_b16 v[52:53], v3 offset:38912
    ds_read_b64_tr_b16 v[54:55], v4 offset:38912
    v_mfma_f32_16x16x32_bf16 v[220:223], v[56:59], v[136:139], v[220:223]
    v_cvt_pk_bf16_f32 v97, v98, v99
    v_mfma_f32_16x16x32_bf16 a[12:15], v[56:59], v[144:147], a[12:15]
    v_exp_f32_e64 v100, v100
    v_mfma_f32_16x16x32_bf16 a[60:63], v[56:59], v[152:155], a[60:63]
    ds_read_b64_tr_b16 v[56:57], v5 offset:38912
    s_waitcnt lgkmcnt(7)
    v_mfma_f32_16x16x32_bf16 v[176:179], v[60:63], v[128:131], v[176:179]
    buffer_load_dwordx4 v16, s[24:27], s46 offen offset:2048 nt lds
    v_mfma_f32_16x16x32_bf16 v[224:227], v[60:63], v[136:139], v[224:227]
    s_add_u32 s46, s46, 12288
    ds_read_b64_tr_b16 v[58:59], v6 offset:38912
    v_mfma_f32_16x16x32_bf16 a[16:19], v[60:63], v[144:147], a[16:19]
    s_mov_b32 s39, s36
    s_mov_b32 s36, s37
    v_mfma_f32_16x16x32_bf16 a[64:67], v[60:63], v[152:155], a[64:67]
    s_mov_b32 s37, s38
    s_mov_b32 s38, s39
    v_mfma_f32_16x16x32_bf16 a[104:107], v[60:63], v[92:95], a[104:107]
    ds_read_b64_tr_b16 v[60:61], v3 offset:39424
    ds_read_b64_tr_b16 v[62:63], v4 offset:39424
    v_mfma_f32_16x16x32_bf16 v[180:183], v[64:67], v[128:131], v[180:183]
    v_exp_f32 v101, v101
    v_mfma_f32_16x16x32_bf16 v[228:231], v[64:67], v[136:139], v[228:231]
    v_add_f32 v17, v17, v100
    v_add_f32 v17, v17, v101
    v_mfma_f32_16x16x32_bf16 a[20:23], v[64:67], v[144:147], a[20:23]
    v_cvt_pk_bf16_f32 v98, v100, v101
    v_mfma_f32_16x16x32_bf16 a[68:71], v[64:67], v[152:155], a[68:71]
    ds_read_b64_tr_b16 v[64:65], v5 offset:39424
    s_waitcnt lgkmcnt(7)
    v_mfma_f32_16x16x32_bf16 v[184:187], v[44:47], v[128:131], v[184:187]
    v_exp_f32 v102, v102
    v_mfma_f32_16x16x32_bf16 v[232:235], v[44:47], v[136:139], v[232:235]
    ds_read_b64_tr_b16 v[66:67], v6 offset:39424
    v_add_f32_e64 v17, v17, v102
    v_mfma_f32_16x16x32_bf16 a[24:27], v[44:47], v[144:147], a[24:27]
    s_waitcnt vmcnt(9)
    s_barrier
    v_mfma_f32_16x16x32_bf16 a[72:75], v[44:47], v[152:155], a[72:75]
    v_exp_f32_e64 v103, v103
    v_mfma_f32_16x16x32_bf16 a[108:111], v[44:47], v[92:95], a[108:111]
    ds_read_b128 v[44:47], v1 offset:24576
    v_add_f32_e64 v17, v17, v103
    v_mfma_f32_16x16x32_bf16 v[188:191], v[48:51], v[128:131], v[188:191]
    v_cvt_pk_bf16_f32 v99, v102, v103
    v_mfma_f32_16x16x32_bf16 v[236:239], v[48:51], v[136:139], v[236:239]
    v_exp_f32_e64 v104, v104
    v_mfma_f32_16x16x32_bf16 a[28:31], v[48:51], v[144:147], a[28:31]
    v_exp_f32_e64 v105, v105
    v_mfma_f32_16x16x32_bf16 a[76:79], v[48:51], v[152:155], a[76:79]
    ds_read_b128 v[48:51], v1 offset:25088
    s_waitcnt lgkmcnt(6)
    v_mfma_f32_16x16x32_bf16 v[192:195], v[52:55], v[128:131], v[192:195]
    v_add_f32 v18, v18, v104
    v_add_f32_e64 v18, v18, v105
    v_mfma_f32_16x16x32_bf16 v[240:243], v[52:55], v[136:139], v[240:243]
    v_cvt_pk_bf16_f32 v104, v104, v105
    v_mfma_f32_16x16x32_bf16 a[32:35], v[52:55], v[144:147], a[32:35]
    v_exp_f32_e64 v106, v106
    v_mfma_f32_16x16x32_bf16 a[80:83], v[52:55], v[152:155], a[80:83]
    v_exp_f32_e64 v107, v107
    v_mfma_f32_16x16x32_bf16 a[112:115], v[52:55], v[92:95], a[112:115]
    ds_read_b128 v[52:55], v1 offset:25600
    v_add_f32_e64 v18, v18, v106
    v_mfma_f32_16x16x32_bf16 v[196:199], v[56:59], v[128:131], v[196:199]
    v_add_f32_e64 v18, v18, v107
    v_cvt_pk_bf16_f32 v105, v106, v107
    v_mfma_f32_16x16x32_bf16 v[244:247], v[56:59], v[136:139], v[244:247]
    v_exp_f32_e64 v108, v108
    v_mfma_f32_16x16x32_bf16 a[36:39], v[56:59], v[144:147], a[36:39]
    v_exp_f32_e64 v109, v109
    v_mfma_f32_16x16x32_bf16 a[84:87], v[56:59], v[152:155], a[84:87]
    ds_read_b128 v[56:59], v1 offset:26112
    s_waitcnt lgkmcnt(4)
    v_mfma_f32_16x16x32_bf16 v[200:203], v[60:63], v[128:131], v[200:203]
    v_add_f32 v18, v18, v108
    v_add_f32_e64 v18, v18, v109
    v_mfma_f32_16x16x32_bf16 v[248:251], v[60:63], v[136:139], v[248:251]
    v_cvt_pk_bf16_f32 v106, v108, v109
    v_mfma_f32_16x16x32_bf16 a[40:43], v[60:63], v[144:147], a[40:43]
    v_mfma_f32_16x16x32_bf16 a[88:91], v[60:63], v[152:155], a[88:91]
    v_mfma_f32_16x16x32_bf16 a[116:119], v[60:63], v[92:95], a[116:119]
    ds_read_b128 v[60:63], v1 offset:26624
    v_mfma_f32_16x16x32_bf16 v[204:207], v[64:67], v[128:131], v[204:207]
    v_mfma_f32_16x16x32_bf16 v[252:255], v[64:67], v[136:139], v[252:255]
    v_mfma_f32_16x16x32_bf16 a[44:47], v[64:67], v[144:147], a[44:47]
    v_mfma_f32_16x16x32_bf16 a[92:95], v[64:67], v[152:155], a[92:95]
    s_branch L_loop
L_tail:
    s_waitcnt lgkmcnt(3)
    v_mfma_f32_16x16x32_bf16 v[96:99], v[44:47], a[120:123], v[68:71]
    v_add_u32 v3, 24576, v9
    v_add_u32 v4, 24576, v10
    v_mfma_f32_16x16x32_bf16 v[104:107], v[44:47], a[144:147], v[72:75]
    v_xor_b32 v5, 32, v3
    v_xor_b32 v6, 32, v4
    v_mfma_f32_16x16x32_bf16 v[88:91], v[44:47], a[216:219], v[84:87]
    ds_read_b128 v[64:67], v1 offset:2560
    ds_read_b128 v[44:47], v2 offset:0
    v_mfma_f32_16x16x32_bf16 v[96:99], v[48:51], a[124:127], v[96:99]
    ds_read_b64 v[94:95], v23 offset:2048
    v_mfma_f32_16x16x32_bf16 v[104:107], v[48:51], a[148:151], v[104:107]
    v_exp_f32_e64 v142, v142
    v_mfma_f32_16x16x32_bf16 v[88:91], v[48:51], a[220:223], v[88:91]
    ds_read_b128 v[48:51], v2 offset:512
    s_waitcnt lgkmcnt(5)
    v_mfma_f32_16x16x32_bf16 v[96:99], v[52:55], a[128:131], v[96:99]
    v_exp_f32 v143, v143
    v_mfma_f32_16x16x32_bf16 v[104:107], v[52:55], a[152:155], v[104:107]
    v_cvt_pk_bf16_f32 v139, v142, v143
    v_add_f32_e64 v18, v18, v142
    v_mfma_f32_16x16x32_bf16 v[88:91], v[52:55], a[224:227], v[88:91]
    ds_read_b128 v[52:55], v2 offset:1024
    v_add_f32_e64 v18, v18, v143
    v_mfma_f32_16x16x32_bf16 v[96:99], v[56:59], a[132:135], v[96:99]
    v_mfma_f32_16x16x32_bf16 v[104:107], v[56:59], a[156:159], v[104:107]
    v_mfma_f32_16x16x32_bf16 v[88:91], v[56:59], a[228:231], v[88:91]
    ds_read_b128 v[56:59], v2 offset:1536
    s_waitcnt lgkmcnt(5)
    v_mfma_f32_16x16x32_bf16 v[96:99], v[60:63], a[136:139], v[96:99]
    v_mfma_f32_16x16x32_bf16 v[104:107], v[60:63], a[160:163], v[104:107]
    v_mfma_f32_16x16x32_bf16 v[88:91], v[60:63], a[232:235], v[88:91]
    ds_read_b128 v[60:63], v2 offset:2048
    v_mfma_f32_16x16x32_bf16 v[96:99], v[64:67], a[140:143], v[96:99]
    v_mfma_f32_16x16x32_bf16 v[104:107], v[64:67], a[164:167], v[104:107]
    v_mfma_f32_16x16x32_bf16 v[88:91], v[64:67], a[236:239], v[88:91]
    ds_read_b128 v[64:67], v2 offset:2560
    s_waitcnt lgkmcnt(4)
    v_mfma_f32_16x16x32_bf16 v[100:103], v[44:47], a[120:123], v[68:71]
    v_mfma_f32_16x16x32_bf16 v[108:111], v[44:47], a[144:147], v[72:75]
    ds_read_b64_tr_b16 v[44:45], v3 offset:12288
    ds_read_b64_tr_b16 v[46:47], v4 offset:12288
    v_mfma_f32_16x16x32_bf16 v[100:103], v[48:51], a[124:127], v[100:103]
    v_exp_f32_e64 v96, v96
    v_mfma_f32_16x16x32_bf16 v[108:111], v[48:51], a[148:151], v[108:111]
    ds_read_b64_tr_b16 v[48:49], v5 offset:12288
    s_waitcnt lgkmcnt(5)
    v_mfma_f32_16x16x32_bf16 v[100:103], v[52:55], a[128:131], v[100:103]
    ds_read_b64_tr_b16 v[50:51], v6 offset:12288
    v_add_f32 v17, v17, v96
    v_mfma_f32_16x16x32_bf16 v[108:111], v[52:55], a[152:155], v[108:111]
    ds_read_b64_tr_b16 v[52:53], v3 offset:12800
    ds_read_b64_tr_b16 v[54:55], v4 offset:12800
    v_mfma_f32_16x16x32_bf16 v[100:103], v[56:59], a[132:135], v[100:103]
    v_exp_f32_e64 v88, v88
    v_mfma_f32_16x16x32_bf16 v[108:111], v[56:59], a[156:159], v[108:111]
    ds_read_b64_tr_b16 v[56:57], v5 offset:12800
    s_waitcnt lgkmcnt(7)
    v_mfma_f32_16x16x32_bf16 v[100:103], v[60:63], a[136:139], v[100:103]
    ds_read_b64_tr_b16 v[58:59], v6 offset:12800
    v_add_f32 v21, v21, v88
    v_mfma_f32_16x16x32_bf16 v[108:111], v[60:63], a[160:163], v[108:111]
    ds_read_b64_tr_b16 v[60:61], v3 offset:13312
    ds_read_b64_tr_b16 v[62:63], v4 offset:13312
    v_mfma_f32_16x16x32_bf16 v[100:103], v[64:67], a[140:143], v[100:103]
    v_exp_f32_e64 v89, v89
    v_mfma_f32_16x16x32_bf16 v[108:111], v[64:67], a[164:167], v[108:111]
    ds_read_b64_tr_b16 v[64:65], v5 offset:13312
    s_waitcnt lgkmcnt(7)
    v_mfma_f32_16x16x32_bf16 v[160:163], v[44:47], v[128:131], v[160:163]
    ds_read_b64_tr_b16 v[66:67], v6 offset:13312
    v_add_f32 v21, v21, v89
    v_mfma_f32_16x16x32_bf16 v[208:211], v[44:47], v[136:139], v[208:211]
    v_cvt_pk_bf16_f32 v88, v88, v89
    v_mfma_f32_16x16x32_bf16 a[96:99], v[44:47], v[92:95], a[96:99]
    ds_read_b64_tr_b16 v[44:45], v3 offset:13824
    ds_read_b64_tr_b16 v[46:47], v4 offset:13824
    v_mfma_f32_16x16x32_bf16 v[164:167], v[48:51], v[128:131], v[164:167]
    v_exp_f32_e64 v90, v90
    v_mfma_f32_16x16x32_bf16 v[212:215], v[48:51], v[136:139], v[212:215]
    ds_read_b64_tr_b16 v[48:49], v5 offset:13824
    s_waitcnt lgkmcnt(7)
    v_mfma_f32_16x16x32_bf16 v[168:171], v[52:55], v[128:131], v[168:171]
    ds_read_b64_tr_b16 v[50:51], v6 offset:13824
    v_add_f32 v21, v21, v90
    v_mfma_f32_16x16x32_bf16 v[216:219], v[52:55], v[136:139], v[216:219]
    v_exp_f32_e64 v91, v91
    v_mfma_f32_16x16x32_bf16 a[100:103], v[52:55], v[92:95], a[100:103]
    ds_read_b64_tr_b16 v[52:53], v3 offset:14336
    ds_read_b64_tr_b16 v[54:55], v4 offset:14336
    v_mfma_f32_16x16x32_bf16 v[172:175], v[56:59], v[128:131], v[172:175]
    v_cvt_pk_bf16_f32 v89, v90, v91
    v_add_f32_e64 v21, v21, v91
    v_mfma_f32_16x16x32_bf16 v[220:223], v[56:59], v[136:139], v[220:223]
    ds_read_b64_tr_b16 v[56:57], v5 offset:14336
    s_waitcnt lgkmcnt(7)
    v_mfma_f32_16x16x32_bf16 v[176:179], v[60:63], v[128:131], v[176:179]
    ds_write_b64 v22, v[88:89] offset:0
    v_mfma_f32_16x16x32_bf16 v[224:227], v[60:63], v[136:139], v[224:227]
    ds_read_b64_tr_b16 v[58:59], v6 offset:14336
    v_mfma_f32_16x16x32_bf16 a[104:107], v[60:63], v[92:95], a[104:107]
    ds_read_b64_tr_b16 v[60:61], v3 offset:14848
    ds_read_b64_tr_b16 v[62:63], v4 offset:14848
    v_mfma_f32_16x16x32_bf16 v[180:183], v[64:67], v[128:131], v[180:183]
    v_exp_f32 v97, v97
    v_mfma_f32_16x16x32_bf16 v[228:231], v[64:67], v[136:139], v[228:231]
    ds_read_b64_tr_b16 v[64:65], v5 offset:14848
    s_waitcnt lgkmcnt(8)
    v_mfma_f32_16x16x32_bf16 v[184:187], v[44:47], v[128:131], v[184:187]
    ds_read_b64_tr_b16 v[66:67], v6 offset:14848
    v_add_f32 v17, v17, v97
    v_mfma_f32_16x16x32_bf16 v[232:235], v[44:47], v[136:139], v[232:235]
    s_waitcnt vmcnt(3) lgkmcnt(5)
    s_barrier
    v_mfma_f32_16x16x32_bf16 a[108:111], v[44:47], v[92:95], a[108:111]
    ds_read_b128 v[44:47], v1 offset:24576
    v_cvt_pk_bf16_f32 v96, v96, v97
    v_mfma_f32_16x16x32_bf16 v[188:191], v[48:51], v[128:131], v[188:191]
    v_exp_f32_e64 v98, v98
    v_mfma_f32_16x16x32_bf16 v[236:239], v[48:51], v[136:139], v[236:239]
    ds_read_b128 v[48:51], v1 offset:25088
    v_add_f32_e64 v17, v17, v98
    v_mfma_f32_16x16x32_bf16 v[192:195], v[52:55], v[128:131], v[192:195]
    v_exp_f32_e64 v99, v99
    v_mfma_f32_16x16x32_bf16 v[240:243], v[52:55], v[136:139], v[240:243]
    v_add_f32_e64 v17, v17, v99
    v_cvt_pk_bf16_f32 v97, v98, v99
    v_mfma_f32_16x16x32_bf16 a[112:115], v[52:55], v[92:95], a[112:115]
    ds_read_b128 v[52:55], v1 offset:25600
    s_waitcnt lgkmcnt(5)
    v_mfma_f32_16x16x32_bf16 v[196:199], v[56:59], v[128:131], v[196:199]
    v_exp_f32 v100, v100
    v_mfma_f32_16x16x32_bf16 v[244:247], v[56:59], v[136:139], v[244:247]
    ds_read_b128 v[56:59], v1 offset:26112
    v_add_f32_e64 v17, v17, v100
    v_mfma_f32_16x16x32_bf16 v[200:203], v[60:63], v[128:131], v[200:203]
    v_exp_f32_e64 v101, v101
    v_mfma_f32_16x16x32_bf16 v[248:251], v[60:63], v[136:139], v[248:251]
    v_add_f32_e64 v17, v17, v101
    v_cvt_pk_bf16_f32 v98, v100, v101
    v_mfma_f32_16x16x32_bf16 a[116:119], v[60:63], v[92:95], a[116:119]
    ds_read_b128 v[60:63], v1 offset:26624
    s_waitcnt lgkmcnt(4)
    v_mfma_f32_16x16x32_bf16 v[204:207], v[64:67], v[128:131], v[204:207]
    v_exp_f32 v102, v102
    v_mfma_f32_16x16x32_bf16 v[252:255], v[64:67], v[136:139], v[252:255]
    v_exp_f32 v103, v103
    v_add_f32 v17, v17, v102
    v_add_f32_e64 v17, v17, v103
    v_cvt_pk_bf16_f32 v99, v102, v103
    s_waitcnt lgkmcnt(3)
    v_mfma_f32_16x16x32_bf16 v[128:131], v[44:47], a[120:123], v[68:71]
    ds_read_b128 v[64:67], v1 offset:27136
    ds_read_b64 v[90:91], v23 offset:0
    v_mfma_f32_16x16x32_bf16 v[136:139], v[44:47], a[144:147], v[72:75]
    v_exp_f32 v104, v104
    v_mfma_f32_16x16x32_bf16 v[92:95], v[44:47], a[216:219], v[84:87]
    ds_read_b128 v[44:47], v2 offset:24576
    v_add_f32_e64 v18, v18, v104
    v_mfma_f32_16x16x32_bf16 v[128:131], v[48:51], a[124:127], v[128:131]
    v_exp_f32_e64 v105, v105
    v_mfma_f32_16x16x32_bf16 v[136:139], v[48:51], a[148:151], v[136:139]
    v_add_f32_e64 v18, v18, v105
    v_cvt_pk_bf16_f32 v104, v104, v105
    v_mfma_f32_16x16x32_bf16 v[92:95], v[48:51], a[220:223], v[92:95]
    ds_read_b128 v[48:51], v2 offset:25088
    s_waitcnt lgkmcnt(5)
    v_mfma_f32_16x16x32_bf16 v[128:131], v[52:55], a[128:131], v[128:131]
    v_exp_f32 v106, v106
    v_mfma_f32_16x16x32_bf16 v[136:139], v[52:55], a[152:155], v[136:139]
    v_exp_f32_e64 v107, v107
    v_mfma_f32_16x16x32_bf16 v[92:95], v[52:55], a[224:227], v[92:95]
    ds_read_b128 v[52:55], v2 offset:25600
    v_add_f32_e64 v18, v18, v106
    v_mfma_f32_16x16x32_bf16 v[128:131], v[56:59], a[132:135], v[128:131]
    v_add_f32_e64 v18, v18, v107
    v_cvt_pk_bf16_f32 v105, v106, v107
    v_mfma_f32_16x16x32_bf16 v[136:139], v[56:59], a[156:159], v[136:139]
    v_exp_f32_e64 v108, v108
    v_mfma_f32_16x16x32_bf16 v[92:95], v[56:59], a[228:231], v[92:95]
    ds_read_b128 v[56:59], v2 offset:26112
    s_waitcnt lgkmcnt(5)
    v_mfma_f32_16x16x32_bf16 v[128:131], v[60:63], a[136:139], v[128:131]
    v_exp_f32 v109, v109
    v_mfma_f32_16x16x32_bf16 v[136:139], v[60:63], a[160:163], v[136:139]
    v_cvt_pk_bf16_f32 v106, v108, v109
    v_add_f32_e64 v18, v18, v108
    v_mfma_f32_16x16x32_bf16 v[92:95], v[60:63], a[232:235], v[92:95]
    ds_read_b128 v[60:63], v2 offset:26624
    v_add_f32_e64 v18, v18, v109
    v_mfma_f32_16x16x32_bf16 v[128:131], v[64:67], a[140:143], v[128:131]
    v_exp_f32_e64 v110, v110
    v_mfma_f32_16x16x32_bf16 v[136:139], v[64:67], a[164:167], v[136:139]
    v_exp_f32_e64 v111, v111
    v_mfma_f32_16x16x32_bf16 v[92:95], v[64:67], a[236:239], v[92:95]
    ds_read_b128 v[64:67], v2 offset:27136
    s_waitcnt lgkmcnt(4)
    v_mfma_f32_16x16x32_bf16 v[132:135], v[44:47], a[120:123], v[68:71]
    v_cvt_pk_bf16_f32 v107, v110, v111
    v_add_f32 v18, v18, v110
    v_mfma_f32_16x16x32_bf16 v[140:143], v[44:47], a[144:147], v[72:75]
    ds_read_b64_tr_b16 v[44:45], v3 offset:36864
    ds_read_b64_tr_b16 v[46:47], v4 offset:36864
    v_mfma_f32_16x16x32_bf16 v[132:135], v[48:51], a[124:127], v[132:135]
    v_exp_f32_e64 v92, v92
    v_mfma_f32_16x16x32_bf16 v[140:143], v[48:51], a[148:151], v[140:143]
    ds_read_b64_tr_b16 v[48:49], v5 offset:36864
    s_waitcnt lgkmcnt(5)
    v_mfma_f32_16x16x32_bf16 v[132:135], v[52:55], a[128:131], v[132:135]
    ds_read_b64_tr_b16 v[50:51], v6 offset:36864
    v_add_f32 v21, v21, v92
    v_mfma_f32_16x16x32_bf16 v[140:143], v[52:55], a[152:155], v[140:143]
    ds_read_b64_tr_b16 v[52:53], v3 offset:37376
    ds_read_b64_tr_b16 v[54:55], v4 offset:37376
    v_mfma_f32_16x16x32_bf16 v[132:135], v[56:59], a[132:135], v[132:135]
    v_exp_f32_e64 v93, v93
    v_mfma_f32_16x16x32_bf16 v[140:143], v[56:59], a[156:159], v[140:143]
    ds_read_b64_tr_b16 v[56:57], v5 offset:37376
    s_waitcnt lgkmcnt(7)
    v_mfma_f32_16x16x32_bf16 v[132:135], v[60:63], a[136:139], v[132:135]
    ds_read_b64_tr_b16 v[58:59], v6 offset:37376
    v_add_f32 v21, v21, v93
    v_mfma_f32_16x16x32_bf16 v[140:143], v[60:63], a[160:163], v[140:143]
    ds_read_b64_tr_b16 v[60:61], v3 offset:37888
    ds_read_b64_tr_b16 v[62:63], v4 offset:37888
    v_mfma_f32_16x16x32_bf16 v[132:135], v[64:67], a[140:143], v[132:135]
    v_exp_f32_e64 v94, v94
    v_mfma_f32_16x16x32_bf16 v[140:143], v[64:67], a[164:167], v[140:143]
    ds_read_b64_tr_b16 v[64:65], v5 offset:37888
    s_waitcnt lgkmcnt(7)
    v_mfma_f32_16x16x32_bf16 v[160:163], v[44:47], v[96:99], v[160:163]
    ds_read_b64_tr_b16 v[66:67], v6 offset:37888
    v_add_f32 v21, v21, v94
    v_mfma_f32_16x16x32_bf16 v[208:211], v[44:47], v[104:107], v[208:211]
    v_exp_f32_e64 v95, v95
    v_mfma_f32_16x16x32_bf16 a[96:99], v[44:47], v[88:91], a[96:99]
    ds_read_b64_tr_b16 v[44:45], v3 offset:38400
    ds_read_b64_tr_b16 v[46:47], v4 offset:38400
    v_mfma_f32_16x16x32_bf16 v[164:167], v[48:51], v[96:99], v[164:167]
    v_add_f32_e64 v21, v21, v95
    v_cvt_pk_bf16_f32 v92, v92, v93
    v_mfma_f32_16x16x32_bf16 v[212:215], v[48:51], v[104:107], v[212:215]
    ds_read_b64_tr_b16 v[48:49], v5 offset:38400
    s_waitcnt lgkmcnt(7)
    v_mfma_f32_16x16x32_bf16 v[168:171], v[52:55], v[96:99], v[168:171]
    ds_read_b64_tr_b16 v[50:51], v6 offset:38400
    v_cvt_pk_bf16_f32 v93, v94, v95
    v_mfma_f32_16x16x32_bf16 v[216:219], v[52:55], v[104:107], v[216:219]
    ds_write_b32 v41, v21 offset:0
    v_mfma_f32_16x16x32_bf16 a[100:103], v[52:55], v[88:91], a[100:103]
    ds_read_b64_tr_b16 v[52:53], v3 offset:38912
    ds_read_b64_tr_b16 v[54:55], v4 offset:38912
    v_mfma_f32_16x16x32_bf16 v[172:175], v[56:59], v[96:99], v[172:175]
    ds_write_b64 v22, v[92:93] offset:2048
    v_mfma_f32_16x16x32_bf16 v[220:223], v[56:59], v[104:107], v[220:223]
    ds_read_b64_tr_b16 v[56:57], v5 offset:38912
    s_waitcnt lgkmcnt(9)
    v_mfma_f32_16x16x32_bf16 v[176:179], v[60:63], v[96:99], v[176:179]
    ds_read_b64_tr_b16 v[58:59], v6 offset:38912
    v_add_f32_e64 v18, v18, v111
    v_mfma_f32_16x16x32_bf16 v[224:227], v[60:63], v[104:107], v[224:227]
    v_exp_f32_e64 v128, v128
    v_mfma_f32_16x16x32_bf16 a[104:107], v[60:63], v[88:91], a[104:107]
    ds_read_b64_tr_b16 v[60:61], v3 offset:39424
    ds_read_b64_tr_b16 v[62:63], v4 offset:39424
    v_mfma_f32_16x16x32_bf16 v[180:183], v[64:67], v[96:99], v[180:183]
    v_exp_f32_e64 v129, v129
    v_mfma_f32_16x16x32_bf16 v[228:231], v[64:67], v[104:107], v[228:231]
    ds_read_b64_tr_b16 v[64:65], v5 offset:39424
    s_waitcnt lgkmcnt(9)
    v_mfma_f32_16x16x32_bf16 v[184:187], v[44:47], v[96:99], v[184:187]
    ds_read_b64_tr_b16 v[66:67], v6 offset:39424
    v_add_f32 v17, v17, v128
    v_mfma_f32_16x16x32_bf16 v[232:235], v[44:47], v[104:107], v[232:235]
    s_waitcnt vmcnt(0) lgkmcnt(6)
    s_barrier
    v_mfma_f32_16x16x32_bf16 a[108:111], v[44:47], v[88:91], a[108:111]
    v_add_f32_e64 v17, v17, v129
    v_cvt_pk_bf16_f32 v128, v128, v129
    v_mfma_f32_16x16x32_bf16 v[188:191], v[48:51], v[96:99], v[188:191]
    v_exp_f32_e64 v130, v130
    v_mfma_f32_16x16x32_bf16 v[236:239], v[48:51], v[104:107], v[236:239]
    v_exp_f32_e64 v131, v131
    v_mfma_f32_16x16x32_bf16 v[192:195], v[52:55], v[96:99], v[192:195]
    v_add_f32 v17, v17, v130
    v_add_f32 v17, v17, v131
    v_mfma_f32_16x16x32_bf16 v[240:243], v[52:55], v[104:107], v[240:243]
    v_cvt_pk_bf16_f32 v129, v130, v131
    v_mfma_f32_16x16x32_bf16 a[112:115], v[52:55], v[88:91], a[112:115]
    s_waitcnt lgkmcnt(4)
    v_mfma_f32_16x16x32_bf16 v[196:199], v[56:59], v[96:99], v[196:199]
    v_exp_f32 v132, v132
    v_mfma_f32_16x16x32_bf16 v[244:247], v[56:59], v[104:107], v[244:247]
    v_add_f32 v17, v17, v132
    s_waitcnt lgkmcnt(2)
    v_mfma_f32_16x16x32_bf16 v[200:203], v[60:63], v[96:99], v[200:203]
    v_exp_f32_e64 v133, v133
    v_mfma_f32_16x16x32_bf16 v[248:251], v[60:63], v[104:107], v[248:251]
    v_add_f32_e64 v17, v17, v133
    v_cvt_pk_bf16_f32 v130, v132, v133
    v_mfma_f32_16x16x32_bf16 a[116:119], v[60:63], v[88:91], a[116:119]
    s_waitcnt lgkmcnt(0)
    v_mfma_f32_16x16x32_bf16 v[204:207], v[64:67], v[96:99], v[204:207]
    v_exp_f32 v134, v134
    v_mfma_f32_16x16x32_bf16 v[252:255], v[64:67], v[104:107], v[252:255]
    v_exp_f32 v135, v135
    v_add_f32 v17, v17, v134
    v_add_f32_e64 v17, v17, v135
    v_cvt_pk_bf16_f32 v131, v134, v135
    ds_read_b64_tr_b16 a[120:121], v3 offset:61440
    ds_read_b64_tr_b16 a[122:123], v4 offset:61440
    ds_read_b64_tr_b16 a[124:125], v5 offset:61440
    ds_read_b64_tr_b16 a[126:127], v6 offset:61440
    ds_read_b64_tr_b16 a[128:129], v3 offset:61952
    ds_read_b64_tr_b16 a[130:131], v4 offset:61952
    ds_read_b64_tr_b16 a[132:133], v5 offset:61952
    ds_read_b64_tr_b16 a[134:135], v6 offset:61952
    ds_read_b64_tr_b16 a[136:137], v3 offset:62464
    ds_read_b64_tr_b16 a[138:139], v4 offset:62464
    ds_read_b64_tr_b16 a[140:141], v5 offset:62464
    ds_read_b64_tr_b16 a[142:143], v6 offset:62464
    ds_read_b64_tr_b16 a[144:145], v3 offset:62976
    ds_read_b64_tr_b16 a[146:147], v4 offset:62976
    ds_read_b64_tr_b16 a[148:149], v5 offset:62976
    s_waitcnt lgkmcnt(11)
    ds_read_b64_tr_b16 a[150:151], v6 offset:62976
    ds_read_b64_tr_b16 a[152:153], v3 offset:63488
    ds_read_b64_tr_b16 a[154:155], v4 offset:63488
    ds_read_b64_tr_b16 a[156:157], v5 offset:63488
    s_waitcnt lgkmcnt(11)
    ds_read_b64_tr_b16 a[158:159], v6 offset:63488
    ds_read_b64_tr_b16 a[160:161], v3 offset:64000
    ds_read_b64_tr_b16 a[162:163], v4 offset:64000
    ds_read_b64_tr_b16 a[164:165], v5 offset:64000
    s_waitcnt lgkmcnt(11)
    ds_read_b64_tr_b16 a[166:167], v6 offset:64000
    ds_read_b64 v[94:95], v23 offset:2048
    v_xor_b32 v87, 512, v41
    ds_read_b32 v86, v87 offset:0
    v_mov_b32 v25, v17
    ds_read_b128 v[44:47], v1 offset:0
    s_waitcnt lgkmcnt(11)
    ds_read_b128 v[48:51], v1 offset:512
    v_permlane16_swap_b32 v17, v25
    v_add_f32 v17, v17, v25
    v_mov_b32 v25, v17
    ds_read_b128 v[52:55], v1 offset:1024
    ds_read_b128 v[56:59], v1 offset:1536
    v_permlane32_swap_b32 v17, v25
    v_add_f32 v17, v17, v25
    v_rcp_f32_e64 v24, v17
    v_mfma_f32_16x16x32_bf16 v[160:163], a[120:123], v[128:131], v[160:163]
    ds_read_b128 v[60:63], v1 offset:2048
    s_waitcnt lgkmcnt(8)
    ds_read_b128 v[64:67], v1 offset:2560
    v_mfma_f32_16x16x32_bf16 v[164:167], a[124:127], v[128:131], v[164:167]
    ds_read_b128 a[240:243], v2 offset:0
    ds_read_b128 a[244:247], v2 offset:512
    v_mfma_f32_16x16x32_bf16 v[168:171], a[128:131], v[128:131], v[168:171]
    ds_read_b128 a[248:251], v2 offset:1024
    v_mul_f32 v160, v24, v160
    v_mfma_f32_16x16x32_bf16 v[172:175], a[132:135], v[128:131], v[172:175]
    v_mul_f32 v161, v24, v161
    v_mul_f32 v162, v24, v162
    v_mfma_f32_16x16x32_bf16 v[176:179], a[136:139], v[128:131], v[176:179]
    v_mul_f32_e64 v163, v24, v163
    v_cvt_pk_bf16_f32 v160, v160, v161
    v_mfma_f32_16x16x32_bf16 v[180:183], a[140:143], v[128:131], v[180:183]
    v_cvt_pk_bf16_f32 v161, v162, v163
    ds_write_b64 v32, v[160:161] offset:0
    v_mfma_f32_16x16x32_bf16 v[184:187], a[144:147], v[128:131], v[184:187]
    v_mul_f32 v164, v24, v164
    v_mul_f32 v165, v24, v165
    v_mfma_f32_16x16x32_bf16 v[188:191], a[148:151], v[128:131], v[188:191]
    v_mul_f32 v166, v24, v166
    v_mul_f32 v167, v24, v167
    v_mfma_f32_16x16x32_bf16 v[192:195], a[152:155], v[128:131], v[192:195]
    v_cvt_pk_bf16_f32 v164, v164, v165
    v_cvt_pk_bf16_f32 v165, v166, v167
    v_mfma_f32_16x16x32_bf16 v[196:199], a[156:159], v[128:131], v[196:199]
    ds_write_b64 v33, v[164:165] offset:0
    v_mfma_f32_16x16x32_bf16 v[200:203], a[160:163], v[128:131], v[200:203]
    v_mul_f32_e64 v168, v24, v168
    v_mul_f32 v169, v24, v169
    s_waitcnt lgkmcnt(2)
    v_mfma_f32_16x16x32_bf16 v[204:207], a[164:167], v[128:131], v[204:207]
    v_mul_f32 v170, v24, v170
    v_mul_f32 v171, v24, v171
    v_cvt_pk_bf16_f32 v168, v168, v169
    v_cvt_pk_bf16_f32 v169, v170, v171
    ds_write_b64 v34, v[168:169] offset:0
    v_mul_f32 v172, v24, v172
    v_mul_f32 v173, v24, v173
    v_mul_f32 v174, v24, v174
    v_mul_f32 v175, v24, v175
    v_cvt_pk_bf16_f32 v172, v172, v173
    v_cvt_pk_bf16_f32 v173, v174, v175
    ds_write_b64 v35, v[172:173] offset:0
    ds_read_b128 v[96:99], v36 offset:0
    ds_read_b128 v[100:103], v36 offset:12288
    v_mul_f32 v176, v24, v176
    v_mul_f32 v177, v24, v177
    v_mul_f32 v178, v24, v178
    v_mul_f32 v179, v24, v179
    v_cvt_pk_bf16_f32 v176, v176, v177
    v_cvt_pk_bf16_f32 v177, v178, v179
    ds_write_b64 v32, v[176:177] offset:128
    v_mul_f32 v180, v24, v180
    v_mul_f32 v181, v24, v181
    v_mul_f32 v182, v24, v182
    v_mul_f32 v183, v24, v183
    v_cvt_pk_bf16_f32 v180, v180, v181
    v_cvt_pk_bf16_f32 v181, v182, v183
    ds_write_b64 v33, v[180:181] offset:128
    v_exp_f32_e64 v144, v144
    v_mfma_f32_16x16x32_bf16 v[112:115], v[44:47], a[168:171], v[76:79]
    v_mul_f32 v184, v24, v184
    v_mul_f32 v185, v24, v185
    v_mul_f32 v186, v24, v186
    v_mul_f32 v187, v24, v187
    v_cvt_pk_bf16_f32 v184, v184, v185
    v_exp_f32 v145, v145
    s_waitcnt lgkmcnt(2)
    buffer_store_dwordx4 v[96:99], v37, s[28:31], 0 offen offset:0 sc1
    buffer_store_dwordx4 v[100:103], v37, s[28:31], 0 offen offset:3072 sc1
    v_cvt_pk_bf16_f32 v185, v186, v187
    ds_write_b64 v34, v[184:185] offset:128
    v_mfma_f32_16x16x32_bf16 v[120:123], v[44:47], a[192:195], v[80:83]
    v_mul_f32 v188, v24, v188
    v_add_f32 v19, v19, v144
    v_mul_f32 v189, v24, v189
    v_mul_f32 v190, v24, v190
    v_mul_f32_e64 v191, v24, v191
    ds_read_b128 a[252:255], v2 offset:1536
    v_cvt_pk_bf16_f32 v188, v188, v189
    v_cvt_pk_bf16_f32 v189, v190, v191
    v_mfma_f32_16x16x32_bf16 v[112:115], v[48:51], a[172:175], v[112:115]
    ds_write_b64 v35, v[188:189] offset:128
    v_add_f32_e64 v19, v19, v145
    v_cvt_pk_bf16_f32 v144, v144, v145
    ds_read_b128 v[104:107], v36 offset:128
    ds_read_b128 v[108:111], v36 offset:12416
    v_mfma_f32_16x16x32_bf16 v[120:123], v[48:51], a[196:199], v[120:123]
    v_exp_f32_e64 v146, v146
    ds_read_b128 a[216:219], v2 offset:2048
    v_exp_f32_e64 v147, v147
    v_mfma_f32_16x16x32_bf16 v[112:115], v[52:55], a[176:179], v[112:115]
    v_mul_f32 v192, v24, v192
    v_mul_f32 v193, v24, v193
    v_mul_f32 v194, v24, v194
    v_mul_f32 v195, v24, v195
    v_mfma_f32_16x16x32_bf16 v[120:123], v[52:55], a[200:203], v[120:123]
    v_cvt_pk_bf16_f32 v192, v192, v193
    v_cvt_pk_bf16_f32 v193, v194, v195
    ds_write_b64 v32, v[192:193] offset:256
    v_add_f32 v19, v19, v146
    v_add_f32 v19, v19, v147
    v_mul_f32_e64 v196, v24, v196
    ds_read_b128 a[220:223], v2 offset:2560
    v_mul_f32 v197, v24, v197
    v_mul_f32 v198, v24, v198
    v_cvt_pk_bf16_f32 v145, v146, v147
    v_mul_f32_e64 v199, v24, v199
    v_cvt_pk_bf16_f32 v196, v196, v197
    v_mfma_f32_16x16x32_bf16 v[112:115], v[56:59], a[180:183], v[112:115]
    s_waitcnt lgkmcnt(2)
    buffer_store_dwordx4 v[104:107], v37, s[28:31], 0 offen offset:128 sc1
    buffer_store_dwordx4 v[108:111], v37, s[28:31], 0 offen offset:3200 sc1
    v_cvt_pk_bf16_f32 v197, v198, v199
    ds_write_b64 v33, v[196:197] offset:256
    v_exp_f32 v148, v148
    v_mul_f32 v200, v24, v200
    v_mul_f32 v201, v24, v201
    v_mfma_f32_16x16x32_bf16 v[120:123], v[56:59], a[204:207], v[120:123]
    v_mul_f32 v202, v24, v202
    v_mul_f32 v203, v24, v203
    v_cvt_pk_bf16_f32 v200, v200, v201
    v_cvt_pk_bf16_f32 v201, v202, v203
    v_exp_f32_e64 v149, v149
    ds_write_b64 v34, v[200:201] offset:256
    ds_read_b64_tr_b16 a[224:225], v3 offset:12288
    v_mul_f32_e64 v204, v24, v204
    ds_read_b64_tr_b16 a[226:227], v4 offset:12288
    v_mul_f32 v205, v24, v205
    v_mul_f32 v206, v24, v206
    v_add_f32 v19, v19, v148
    v_mul_f32 v207, v24, v207
    v_cvt_pk_bf16_f32 v204, v204, v205
    v_mfma_f32_16x16x32_bf16 v[112:115], v[60:63], a[184:187], v[112:115]
    v_cvt_pk_bf16_f32 v205, v206, v207
    ds_write_b64 v35, v[204:205] offset:256
    v_add_f32_e64 v19, v19, v149
    v_mfma_f32_16x16x32_bf16 v[120:123], v[60:63], a[208:211], v[120:123]
    ds_read_b128 v[96:99], v36 offset:256
    ds_read_b128 v[100:103], v36 offset:12544
    v_cvt_pk_bf16_f32 v146, v148, v149
    v_exp_f32_e64 v150, v150
    ds_read_b64_tr_b16 a[228:229], v5 offset:12288
    ds_read_b64_tr_b16 a[230:231], v6 offset:12288
    v_exp_f32 v151, v151
    v_exp_f32 v136, v136
    v_mfma_f32_16x16x32_bf16 v[112:115], v[64:67], a[188:191], v[112:115]
    v_exp_f32 v137, v137
    v_add_f32 v18, v18, v136
    v_add_f32_e64 v18, v18, v137
    v_mfma_f32_16x16x32_bf16 v[120:123], v[64:67], a[212:215], v[120:123]
    v_cvt_pk_bf16_f32 v136, v136, v137
    v_exp_f32 v138, v138
    v_exp_f32 v139, v139
    v_add_f32 v19, v19, v150
    v_add_f32 v18, v18, v138
    v_add_f32 v19, v19, v151
    v_add_f32 v18, v18, v139
    v_cvt_pk_bf16_f32 v137, v138, v139
    ds_read_b64_tr_b16 a[232:233], v3 offset:12800
    v_exp_f32_e64 v140, v140
    v_cvt_pk_bf16_f32 v147, v150, v151
    v_exp_f32 v141, v141
    s_waitcnt lgkmcnt(1)
    buffer_store_dwordx4 v[96:99], v37, s[28:31], 0 offen offset:256 sc1
    buffer_store_dwordx4 v[100:103], v37, s[28:31], 0 offen offset:3328 sc1
    v_add_f32_e64 v18, v18, v140
    ds_read_b64_tr_b16 a[234:235], v4 offset:12800
    v_add_f32_e64 v18, v18, v141
    v_cvt_pk_bf16_f32 v138, v140, v141
    v_mfma_f32_16x16x32_bf16 v[116:119], a[240:243], a[168:171], v[76:79]
    v_exp_f32 v142, v142
    v_exp_f32 v143, v143
    v_exp_f32 v152, v152
    v_add_f32 v18, v18, v142
    v_add_f32_e64 v18, v18, v143
    v_cvt_pk_bf16_f32 v139, v142, v143
    v_mov_b32_e64 v27, v18
    v_mfma_f32_16x16x32_bf16 v[124:127], a[240:243], a[192:195], v[80:83]
    s_nop 0
    v_permlane16_swap_b32 v18, v27
    v_add_f32 v18, v18, v27
    v_mov_b32 v27, v18
    v_exp_f32 v153, v153
    s_nop 0
    v_permlane32_swap_b32 v18, v27
    v_add_f32 v18, v18, v27
    v_rcp_f32_e64 v26, v18
    v_mfma_f32_16x16x32_bf16 v[208:211], a[120:123], v[136:139], v[208:211]
    ds_read_b64_tr_b16 a[236:237], v5 offset:12800
    v_add_f32_e64 v20, v20, v152
    v_mfma_f32_16x16x32_bf16 v[212:215], a[124:127], v[136:139], v[212:215]
    ds_read_b64_tr_b16 a[238:239], v6 offset:12800
    v_add_f32_e64 v20, v20, v153
    v_mfma_f32_16x16x32_bf16 v[216:219], a[128:131], v[136:139], v[216:219]
    v_cvt_pk_bf16_f32 v152, v152, v153
    v_exp_f32_e64 v154, v154
    v_mfma_f32_16x16x32_bf16 v[220:223], a[132:135], v[136:139], v[220:223]
    ds_read_b64_tr_b16 v[44:45], v3 offset:13312
    v_mul_f32_e64 v208, v26, v208
    v_mfma_f32_16x16x32_bf16 v[116:119], a[244:247], a[172:175], v[116:119]
    v_mul_f32 v209, v26, v209
    v_exp_f32 v155, v155
    v_mfma_f32_16x16x32_bf16 v[224:227], a[136:139], v[136:139], v[224:227]
    v_mul_f32 v210, v26, v210
    v_mul_f32 v211, v26, v211
    v_mfma_f32_16x16x32_bf16 v[228:231], a[140:143], v[136:139], v[228:231]
    v_cvt_pk_bf16_f32 v208, v208, v209
    v_cvt_pk_bf16_f32 v209, v210, v211
    v_mfma_f32_16x16x32_bf16 v[232:235], a[144:147], v[136:139], v[232:235]
    ds_write_b64 v32, v[208:209] offset:0
    v_mfma_f32_16x16x32_bf16 v[236:239], a[148:151], v[136:139], v[236:239]
    ds_read_b64_tr_b16 v[46:47], v4 offset:13312
    v_mul_f32_e64 v212, v26, v212
    v_mfma_f32_16x16x32_bf16 v[124:127], a[244:247], a[196:199], v[124:127]
    v_add_f32 v20, v20, v154
    v_mul_f32 v213, v26, v213
    v_mfma_f32_16x16x32_bf16 v[240:243], a[152:155], v[136:139], v[240:243]
    v_mul_f32 v214, v26, v214
    v_mul_f32 v215, v26, v215
    v_mfma_f32_16x16x32_bf16 v[244:247], a[156:159], v[136:139], v[244:247]
    v_cvt_pk_bf16_f32 v212, v212, v213
    v_cvt_pk_bf16_f32 v213, v214, v215
    v_mfma_f32_16x16x32_bf16 v[248:251], a[160:163], v[136:139], v[248:251]
    ds_write_b64 v33, v[212:213] offset:0
    v_mfma_f32_16x16x32_bf16 v[252:255], a[164:167], v[136:139], v[252:255]
    v_add_f32_e64 v20, v20, v155
    v_cvt_pk_bf16_f32 v153, v154, v155
    v_mfma_f32_16x16x32_bf16 v[116:119], a[248:251], a[176:179], v[116:119]
    ds_read_b64_tr_b16 v[48:49], v5 offset:13312
    v_mul_f32_e64 v216, v26, v216
    v_mfma_f32_16x16x32_bf16 v[124:127], a[248:251], a[200:203], v[124:127]
    v_mul_f32_e64 v217, v26, v217
    ds_read_b64_tr_b16 v[50:51], v6 offset:13312
    v_mul_f32 v218, v26, v218
    v_mul_f32 v219, v26, v219
    v_exp_f32_e64 v156, v156
    v_cvt_pk_bf16_f32 v216, v216, v217
    v_cvt_pk_bf16_f32 v217, v218, v219
    ds_write_b64 v34, v[216:217] offset:0
    v_mfma_f32_16x16x32_bf16 v[116:119], a[252:255], a[180:183], v[116:119]
    v_mul_f32 v220, v26, v220
    v_exp_f32 v157, v157
    v_mul_f32 v221, v26, v221
    v_mul_f32 v222, v26, v222
    v_mul_f32_e64 v223, v26, v223
    v_cvt_pk_bf16_f32 v220, v220, v221
    v_mfma_f32_16x16x32_bf16 v[124:127], a[252:255], a[204:207], v[124:127]
    v_cvt_pk_bf16_f32 v221, v222, v223
    ds_write_b64 v35, v[220:221] offset:0
    v_add_f32_e64 v20, v20, v156
    ds_read_b64_tr_b16 v[52:53], v3 offset:13824
    ds_read_b128 v[104:107], v36 offset:0
    ds_read_b128 v[108:111], v36 offset:12288
    s_waitcnt lgkmcnt(5)
    ds_read_b64_tr_b16 v[54:55], v4 offset:13824
    v_add_f32 v20, v20, v157
    v_mfma_f32_16x16x32_bf16 v[116:119], a[216:219], a[184:187], v[116:119]
    v_cvt_pk_bf16_f32 v154, v156, v157
    v_exp_f32_e64 v158, v158
    v_mfma_f32_16x16x32_bf16 v[124:127], a[216:219], a[208:211], v[124:127]
    v_mul_f32 v224, v26, v224
    v_mul_f32 v225, v26, v225
    v_mul_f32 v226, v26, v226
    v_mul_f32 v227, v26, v227
    v_exp_f32_e64 v159, v159
    v_cvt_pk_bf16_f32 v224, v224, v225
    v_cvt_pk_bf16_f32 v225, v226, v227
    ds_write_b64 v32, v[224:225] offset:128
    ds_read_b64_tr_b16 v[56:57], v5 offset:13824
    ds_read_b64_tr_b16 v[58:59], v6 offset:13824
    v_mul_f32_e64 v228, v26, v228
    v_mfma_f32_16x16x32_bf16 v[116:119], a[220:223], a[188:191], v[116:119]
    v_mul_f32 v229, v26, v229
    v_mul_f32 v230, v26, v230
    v_mul_f32_e64 v231, v26, v231
    v_cvt_pk_bf16_f32 v228, v228, v229
    v_add_f32_e64 v20, v20, v158
    v_cvt_pk_bf16_f32 v229, v230, v231
    s_waitcnt lgkmcnt(3)
    buffer_store_dwordx4 v[104:107], v37, s[28:31], s64 offen offset:0 sc1
    buffer_store_dwordx4 v[108:111], v37, s[28:31], s64 offen offset:3072 sc1
    ds_write_b64 v33, v[228:229] offset:128
    v_add_f32 v20, v20, v159
    v_mfma_f32_16x16x32_bf16 v[124:127], a[220:223], a[212:215], v[124:127]
    v_mul_f32 v232, v26, v232
    v_mul_f32 v233, v26, v233
    v_cvt_pk_bf16_f32 v155, v158, v159
    v_mul_f32 v234, v26, v234
    v_mul_f32 v235, v26, v235
    ds_read_b64_tr_b16 v[60:61], v3 offset:14336
    v_cvt_pk_bf16_f32 v232, v232, v233
    v_cvt_pk_bf16_f32 v233, v234, v235
    v_exp_f32_e64 v112, v112
    ds_write_b64 v34, v[232:233] offset:128
    ds_read_b64_tr_b16 v[62:63], v4 offset:14336
    v_mul_f32_e64 v236, v26, v236
    v_mfma_f32_16x16x32_bf16 a[0:3], a[224:227], v[144:147], a[0:3]
    v_mul_f32 v237, v26, v237
    v_mul_f32 v238, v26, v238
    v_mul_f32_e64 v239, v26, v239
    v_cvt_pk_bf16_f32 v236, v236, v237
    v_mfma_f32_16x16x32_bf16 a[48:51], a[224:227], v[152:155], a[48:51]
    v_cvt_pk_bf16_f32 v237, v238, v239
    ds_write_b64 v35, v[236:237] offset:128
    ds_read_b64_tr_b16 v[64:65], v5 offset:14336
    ds_read_b64_tr_b16 v[66:67], v6 offset:14336
    ds_read_b128 v[96:99], v36 offset:128
    ds_read_b128 v[100:103], v36 offset:12416
    v_exp_f32_e64 v113, v113
    v_mfma_f32_16x16x32_bf16 a[4:7], a[228:231], v[144:147], a[4:7]
    ds_read_b64_tr_b16 a[240:241], v3 offset:14848
    ds_read_b64_tr_b16 a[242:243], v4 offset:14848
    v_mfma_f32_16x16x32_bf16 a[52:55], a[228:231], v[152:155], a[52:55]
    v_mul_f32 v240, v26, v240
    v_mul_f32 v241, v26, v241
    v_mfma_f32_16x16x32_bf16 a[8:11], a[232:235], v[144:147], a[8:11]
    v_mul_f32 v242, v26, v242
    v_mul_f32 v243, v26, v243
    v_cvt_pk_bf16_f32 v240, v240, v241
    v_cvt_pk_bf16_f32 v241, v242, v243
    v_add_f32_e64 v19, v19, v112
    ds_write_b64 v32, v[240:241] offset:256
    v_mfma_f32_16x16x32_bf16 a[56:59], a[232:235], v[152:155], a[56:59]
    s_waitcnt lgkmcnt(7)
    ds_read_b64_tr_b16 a[244:245], v5 offset:14848
    v_mul_f32 v244, v26, v244
    v_mul_f32 v245, v26, v245
    v_mul_f32 v246, v26, v246
    ds_read_b64_tr_b16 a[246:247], v6 offset:14848
    v_mul_f32_e64 v247, v26, v247
    v_cvt_pk_bf16_f32 v244, v244, v245
    v_add_f32_e64 v19, v19, v113
    v_cvt_pk_bf16_f32 v245, v246, v247
    s_waitcnt lgkmcnt(3)
    buffer_store_dwordx4 v[96:99], v37, s[28:31], s64 offen offset:128 sc1
    buffer_store_dwordx4 v[100:103], v37, s[28:31], s64 offen offset:3200 sc1
    ds_write_b64 v33, v[244:245] offset:256
    v_mfma_f32_16x16x32_bf16 a[12:15], a[236:239], v[144:147], a[12:15]
    v_mul_f32 v248, v26, v248
    v_mul_f32_e64 v249, v26, v249
    v_mfma_f32_16x16x32_bf16 a[60:63], a[236:239], v[152:155], a[60:63]
    v_mul_f32 v250, v26, v250
    v_mul_f32 v251, v26, v251
    v_cvt_pk_bf16_f32 v112, v112, v113
    v_cvt_pk_bf16_f32 v248, v248, v249
    v_cvt_pk_bf16_f32 v249, v250, v251
    ds_read_b128 v[160:163], v1 offset:24576
    ds_write_b64 v34, v[248:249] offset:256
    v_mfma_f32_16x16x32_bf16 a[16:19], v[44:47], v[144:147], a[16:19]
    v_mul_f32 v252, v26, v252
    v_mul_f32 v253, v26, v253
    v_mfma_f32_16x16x32_bf16 a[64:67], v[44:47], v[152:155], a[64:67]
    v_mul_f32 v254, v26, v254
    v_mul_f32 v255, v26, v255
    v_cvt_pk_bf16_f32 v252, v252, v253
    v_exp_f32_e64 v114, v114
    v_cvt_pk_bf16_f32 v253, v254, v255
    ds_write_b64 v35, v[252:253] offset:256
    ds_read_b128 v[164:167], v1 offset:25088
    v_mfma_f32_16x16x32_bf16 a[20:23], v[48:51], v[144:147], a[20:23]
    ds_read_b128 v[104:107], v36 offset:256
    ds_read_b128 v[108:111], v36 offset:12544
    v_mfma_f32_16x16x32_bf16 a[68:71], v[48:51], v[152:155], a[68:71]
    ds_read_b128 v[168:171], v1 offset:25600
    v_exp_f32_e64 v115, v115
    v_mfma_f32_16x16x32_bf16 a[24:27], v[52:55], v[144:147], a[24:27]
    ds_read_b128 v[172:175], v1 offset:26112
    v_add_f32_e64 v21, v21, v86
    v_mfma_f32_16x16x32_bf16 a[96:99], a[120:123], v[92:95], a[96:99]
    v_mov_b32 v85, v21
    v_add_f32 v19, v19, v114
    v_mfma_f32_16x16x32_bf16 a[72:75], v[52:55], v[152:155], a[72:75]
    v_permlane16_swap_b32 v21, v85
    v_add_f32 v21, v21, v85
    v_mfma_f32_16x16x32_bf16 a[100:103], a[128:131], v[92:95], a[100:103]
    v_mov_b32_e64 v85, v21
    ds_read_b128 v[176:179], v1 offset:26624
    v_mfma_f32_16x16x32_bf16 a[104:107], a[136:139], v[92:95], a[104:107]
    v_permlane32_swap_b32 v21, v85
    v_add_f32 v21, v21, v85
    v_mfma_f32_16x16x32_bf16 a[108:111], a[144:147], v[92:95], a[108:111]
    v_rcp_f32_e64 v84, v21
    v_mfma_f32_16x16x32_bf16 a[28:31], v[56:59], v[144:147], a[28:31]
    v_xor_b32_e64 v87, 32, v30
    v_accvgpr_read_b32 v68, a96
    s_waitcnt lgkmcnt(2)
    buffer_store_dwordx4 v[104:107], v37, s[28:31], s64 offen offset:256 sc1
    buffer_store_dwordx4 v[108:111], v37, s[28:31], s64 offen offset:3328 sc1
    v_mfma_f32_16x16x32_bf16 a[112:115], a[152:155], v[92:95], a[112:115]
    v_accvgpr_read_b32 v69, a97
    v_add_f32 v19, v19, v115
    v_mfma_f32_16x16x32_bf16 a[116:119], a[160:163], v[92:95], a[116:119]
    v_accvgpr_read_b32 v70, a98
    v_accvgpr_read_b32 v71, a99
    v_mfma_f32_16x16x32_bf16 a[76:79], v[56:59], v[152:155], a[76:79]
    v_mul_f32 v68, v84, v68
    v_mul_f32 v69, v84, v69
    v_mfma_f32_16x16x32_bf16 a[32:35], v[60:63], v[144:147], a[32:35]
    v_mul_f32 v70, v84, v70
    v_mul_f32 v71, v84, v71
    v_mfma_f32_16x16x32_bf16 a[80:83], v[60:63], v[152:155], a[80:83]
    ds_read_b128 v[180:183], v1 offset:27136
    v_cvt_pk_bf16_f32 v68, v68, v69
    v_cvt_pk_bf16_f32 v69, v70, v71
    v_mfma_f32_16x16x32_bf16 a[36:39], v[64:67], v[144:147], a[36:39]
    ds_write_b64 v30, v[68:69] offset:0
    v_cvt_pk_bf16_f32 v113, v114, v115
    v_accvgpr_read_b32 v72, a100
    v_mfma_f32_16x16x32_bf16 a[84:87], v[64:67], v[152:155], a[84:87]
    v_accvgpr_read_b32 v73, a101
    v_accvgpr_read_b32 v74, a102
    v_accvgpr_read_b32 v75, a103
    v_mul_f32_e64 v72, v84, v72
    ds_read_b128 v[184:187], v2 offset:24576
    v_mul_f32 v73, v84, v73
    v_mul_f32 v74, v84, v74
    v_exp_f32 v116, v116
    v_mul_f32 v75, v84, v75
    v_cvt_pk_bf16_f32 v72, v72, v73
    v_cvt_pk_bf16_f32 v73, v74, v75
    ds_write_b64 v87, v[72:73] offset:0
    v_mfma_f32_16x16x32_bf16 a[40:43], a[240:243], v[144:147], a[40:43]
    v_accvgpr_read_b32 v68, a104
    v_accvgpr_read_b32 v69, a105
    v_mfma_f32_16x16x32_bf16 a[88:91], a[240:243], v[152:155], a[88:91]
    v_accvgpr_read_b32 v70, a106
    v_accvgpr_read_b32 v71, a107
    v_mul_f32_e64 v68, v84, v68
    ds_read_b128 v[188:191], v2 offset:25088
    v_mul_f32 v69, v84, v69
    v_mul_f32 v70, v84, v70
    v_mfma_f32_16x16x32_bf16 a[44:47], a[244:247], v[144:147], a[44:47]
    v_mul_f32_e64 v71, v84, v71
    v_cvt_pk_bf16_f32 v68, v68, v69
    v_cvt_pk_bf16_f32 v69, v70, v71
    ds_write_b64 v30, v[68:69] offset:1024
    v_exp_f32_e64 v117, v117
    v_mfma_f32_16x16x32_bf16 a[92:95], a[244:247], v[152:155], a[92:95]
    v_accvgpr_read_b32 v72, a108
    v_accvgpr_read_b32 v73, a109
    v_accvgpr_read_b32 v74, a110
    v_accvgpr_read_b32 v75, a111
    ds_read_b128 a[248:251], v2 offset:25600
    v_mul_f32 v72, v84, v72
    v_mul_f32 v73, v84, v73
    v_mfma_f32_16x16x32_bf16 v[144:147], v[160:163], a[168:171], v[76:79]
    v_mul_f32 v74, v84, v74
    v_mul_f32 v75, v84, v75
    v_cvt_pk_bf16_f32 v72, v72, v73
    v_cvt_pk_bf16_f32 v73, v74, v75
    ds_read_b128 a[252:255], v2 offset:26112
    ds_write_b64 v87, v[72:73] offset:1024
    v_mfma_f32_16x16x32_bf16 v[144:147], v[164:167], a[172:175], v[144:147]
    v_accvgpr_read_b32 v68, a112
    v_add_f32_e64 v19, v19, v116
    v_accvgpr_read_b32 v69, a113
    v_accvgpr_read_b32 v70, a114
    ds_read_b128 a[216:219], v2 offset:26624
    v_accvgpr_read_b32 v71, a115
    v_mul_f32_e64 v68, v84, v68
    v_mfma_f32_16x16x32_bf16 v[144:147], v[168:171], a[176:179], v[144:147]
    v_mul_f32 v69, v84, v69
    v_mul_f32 v70, v84, v70
    v_mul_f32_e64 v71, v84, v71
    v_cvt_pk_bf16_f32 v68, v68, v69
    ds_read_b128 a[220:223], v2 offset:27136
    v_cvt_pk_bf16_f32 v69, v70, v71
    ds_write_b64 v30, v[68:69] offset:2048
    v_add_f32 v19, v19, v117
    s_waitcnt lgkmcnt(5)
    v_mfma_f32_16x16x32_bf16 v[144:147], v[172:175], a[180:183], v[144:147]
    v_accvgpr_read_b32 v72, a116
    v_accvgpr_read_b32 v73, a117
    ds_read_b64_tr_b16 a[224:225], v3 offset:36864
    v_accvgpr_read_b32 v74, a118
    v_accvgpr_read_b32 v75, a119
    ds_read_b64_tr_b16 a[226:227], v4 offset:36864
    v_mul_f32 v72, v84, v72
    v_mul_f32 v73, v84, v73
    v_cvt_pk_bf16_f32 v114, v116, v117
    v_mul_f32 v74, v84, v74
    v_mul_f32 v75, v84, v75
    v_mfma_f32_16x16x32_bf16 v[144:147], v[176:179], a[184:187], v[144:147]
    v_cvt_pk_bf16_f32 v72, v72, v73
    v_cvt_pk_bf16_f32 v73, v74, v75
    ds_write_b64 v87, v[72:73] offset:2048
    ds_read_b64_tr_b16 a[228:229], v5 offset:36864
    ds_read_b64_tr_b16 a[230:231], v6 offset:36864
    ds_read_b128 v[128:131], v31 offset:0
    v_exp_f32_e64 v118, v118
    ds_read_b128 v[132:135], v31 offset:1024
    ds_read_b128 v[136:139], v31 offset:2048
    v_mfma_f32_16x16x32_bf16 v[144:147], v[180:183], a[188:191], v[144:147]
    ds_read_b64_tr_b16 a[232:233], v3 offset:37376
    ds_read_b64_tr_b16 a[234:235], v4 offset:37376
    v_mfma_f32_16x16x32_bf16 v[148:151], v[184:187], a[168:171], v[76:79]
    s_waitcnt lgkmcnt(8)
    ds_read_b64_tr_b16 a[236:237], v5 offset:37376
    v_exp_f32 v119, v119
    ds_read_b64_tr_b16 a[238:239], v6 offset:37376
    v_mfma_f32_16x16x32_bf16 v[148:151], v[188:191], a[172:175], v[148:151]
    ds_read_b64_tr_b16 v[44:45], v3 offset:37888
    ds_read_b64_tr_b16 v[46:47], v4 offset:37888
    v_mfma_f32_16x16x32_bf16 v[148:151], a[248:251], a[176:179], v[148:151]
    ds_read_b64_tr_b16 v[48:49], v5 offset:37888
    v_add_f32_e64 v19, v19, v118
    ds_read_b64_tr_b16 v[50:51], v6 offset:37888
    v_mfma_f32_16x16x32_bf16 v[148:151], a[252:255], a[180:183], v[148:151]
    ds_read_b64_tr_b16 v[52:53], v3 offset:38400
    v_add_f32 v19, v19, v119
    s_waitcnt lgkmcnt(10)
    ds_read_b64_tr_b16 v[54:55], v4 offset:38400
    v_mfma_f32_16x16x32_bf16 v[148:151], a[216:219], a[184:187], v[148:151]
    ds_read_b64_tr_b16 v[56:57], v5 offset:38400
    v_cvt_pk_bf16_f32 v115, v118, v119
    ds_read_b64_tr_b16 v[58:59], v6 offset:38400
    v_mfma_f32_16x16x32_bf16 v[148:151], a[220:223], a[188:191], v[148:151]
    buffer_store_dwordx4 v[128:131], v40, s[28:31], 0 offen offset:0 sc1
    buffer_store_dwordx4 v[132:135], v40, s[28:31], 0 offen offset:128 sc1
    s_waitcnt lgkmcnt(8)
    buffer_store_dwordx4 v[136:139], v40, s[28:31], 0 offen offset:256 sc1
    ds_read_b64_tr_b16 v[60:61], v3 offset:38912
    v_exp_f32 v144, v144
    ds_read_b64_tr_b16 v[62:63], v4 offset:38912
    v_mfma_f32_16x16x32_bf16 a[0:3], a[224:227], v[112:115], a[0:3]
    v_exp_f32_e64 v145, v145
    ds_read_b64_tr_b16 v[64:65], v5 offset:38912
    v_add_f32_e64 v19, v19, v144
    ds_read_b64_tr_b16 v[66:67], v6 offset:38912
    v_add_f32_e64 v19, v19, v145
    v_mfma_f32_16x16x32_bf16 a[4:7], a[228:231], v[112:115], a[4:7]
    v_cvt_pk_bf16_f32 v144, v144, v145
    ds_read_b64_tr_b16 a[240:241], v3 offset:39424
    v_exp_f32_e64 v146, v146
    ds_read_b64_tr_b16 a[242:243], v4 offset:39424
    v_mfma_f32_16x16x32_bf16 a[8:11], a[232:235], v[112:115], a[8:11]
    v_exp_f32_e64 v147, v147
    ds_read_b64_tr_b16 a[244:245], v5 offset:39424
    v_add_f32 v19, v19, v146
    s_waitcnt lgkmcnt(7)
    ds_read_b64_tr_b16 a[246:247], v6 offset:39424
    v_add_f32_e64 v19, v19, v147
    v_mfma_f32_16x16x32_bf16 a[12:15], a[236:239], v[112:115], a[12:15]
    v_cvt_pk_bf16_f32 v145, v146, v147
    v_exp_f32_e64 v148, v148
    v_mfma_f32_16x16x32_bf16 a[16:19], v[44:47], v[112:115], a[16:19]
    v_exp_f32_e64 v149, v149
    v_mfma_f32_16x16x32_bf16 a[20:23], v[48:51], v[112:115], a[20:23]
    v_add_f32 v19, v19, v148
    v_add_f32 v19, v19, v149
    v_mfma_f32_16x16x32_bf16 a[24:27], v[52:55], v[112:115], a[24:27]
    v_cvt_pk_bf16_f32 v146, v148, v149
    v_exp_f32_e64 v150, v150
    v_mfma_f32_16x16x32_bf16 a[28:31], v[56:59], v[112:115], a[28:31]
    v_exp_f32 v151, v151
    s_waitcnt lgkmcnt(2)
    v_mfma_f32_16x16x32_bf16 a[32:35], v[60:63], v[112:115], a[32:35]
    v_add_f32 v19, v19, v150
    v_add_f32 v19, v19, v151
    v_mfma_f32_16x16x32_bf16 a[36:39], v[64:67], v[112:115], a[36:39]
    v_cvt_pk_bf16_f32 v147, v150, v151
    v_mov_b32_e64 v29, v19
    v_mfma_f32_16x16x32_bf16 a[40:43], a[240:243], v[112:115], a[40:43]
    s_nop 0
    v_permlane16_swap_b32 v19, v29
    v_add_f32 v19, v19, v29
    s_waitcnt lgkmcnt(0)
    v_mfma_f32_16x16x32_bf16 a[44:47], a[244:247], v[112:115], a[44:47]
    v_mov_b32 v29, v19
    v_exp_f32 v120, v120
    s_nop 0
    v_permlane32_swap_b32 v19, v29
    v_add_f32 v19, v19, v29
    v_rcp_f32 v28, v19
    v_mfma_f32_16x16x32_bf16 a[0:3], a[120:123], v[144:147], a[0:3]
    v_exp_f32_e64 v121, v121
    v_mfma_f32_16x16x32_bf16 a[4:7], a[124:127], v[144:147], a[4:7]
    v_add_f32 v20, v20, v120
    v_add_f32 v20, v20, v121
    v_mfma_f32_16x16x32_bf16 a[8:11], a[128:131], v[144:147], a[8:11]
    v_cvt_pk_bf16_f32 v120, v120, v121
    s_nop 1
    v_accvgpr_read_b32 v208, a0
    v_mfma_f32_16x16x32_bf16 a[12:15], a[132:135], v[144:147], a[12:15]
    v_accvgpr_read_b32 v209, a1
    v_accvgpr_read_b32 v210, a2
    v_mfma_f32_16x16x32_bf16 a[16:19], a[136:139], v[144:147], a[16:19]
    v_accvgpr_read_b32 v211, a3
    v_pk_mul_f32 v[208:209], v[208:209], v[28:29] op_sel_hi:[1,0]
    v_mfma_f32_16x16x32_bf16 a[20:23], a[140:143], v[144:147], a[20:23]
    v_pk_mul_f32 v[210:211], v[210:211], v[28:29] op_sel_hi:[1,0]
    v_cvt_pk_bf16_f32 v208, v208, v209
    v_mfma_f32_16x16x32_bf16 a[24:27], a[144:147], v[144:147], a[24:27]
    v_cvt_pk_bf16_f32 v209, v210, v211
    ds_write_b64 v32, v[208:209] offset:0
    v_mfma_f32_16x16x32_bf16 a[28:31], a[148:151], v[144:147], a[28:31]
    v_accvgpr_read_b32 v212, a4
    v_accvgpr_read_b32 v213, a5
    v_mfma_f32_16x16x32_bf16 a[32:35], a[152:155], v[144:147], a[32:35]
    v_accvgpr_read_b32 v214, a6
    v_accvgpr_read_b32 v215, a7
    v_mfma_f32_16x16x32_bf16 a[36:39], a[156:159], v[144:147], a[36:39]
    v_pk_mul_f32 v[212:213], v[212:213], v[28:29] op_sel_hi:[1,0]
    v_pk_mul_f32 v[214:215], v[214:215], v[28:29] op_sel_hi:[1,0]
    v_mfma_f32_16x16x32_bf16 a[40:43], a[160:163], v[144:147], a[40:43]
    v_cvt_pk_bf16_f32 v212, v212, v213
    v_cvt_pk_bf16_f32 v213, v214, v215
    v_mfma_f32_16x16x32_bf16 a[44:47], a[164:167], v[144:147], a[44:47]
    ds_write_b64 v33, v[212:213] offset:0
    v_mfma_f32_16x16x32_bf16 v[152:155], v[160:163], a[192:195], v[80:83]
    v_exp_f32 v122, v122
    v_mfma_f32_16x16x32_bf16 v[152:155], v[164:167], a[196:199], v[152:155]
    v_exp_f32_e64 v123, v123
    v_mfma_f32_16x16x32_bf16 v[152:155], v[168:171], a[200:203], v[152:155]
    v_accvgpr_read_b32 v216, a8
    v_accvgpr_read_b32 v217, a9
    v_mfma_f32_16x16x32_bf16 v[152:155], v[172:175], a[204:207], v[152:155]
    v_accvgpr_read_b32 v218, a10
    v_accvgpr_read_b32 v219, a11
    v_mfma_f32_16x16x32_bf16 v[152:155], v[176:179], a[208:211], v[152:155]
    v_pk_mul_f32 v[216:217], v[216:217], v[28:29] op_sel_hi:[1,0]
    v_pk_mul_f32 v[218:219], v[218:219], v[28:29] op_sel_hi:[1,0]
    v_add_f32_e64 v20, v20, v122
    v_cvt_pk_bf16_f32 v216, v216, v217
    v_cvt_pk_bf16_f32 v217, v218, v219
    v_mfma_f32_16x16x32_bf16 v[152:155], v[180:183], a[212:215], v[152:155]
    ds_write_b64 v34, v[216:217] offset:0
    v_add_f32_e64 v20, v20, v123
    v_cvt_pk_bf16_f32 v121, v122, v123
    v_accvgpr_read_b32 v220, a12
    v_mfma_f32_16x16x32_bf16 v[156:159], v[184:187], a[192:195], v[80:83]
    v_accvgpr_read_b32 v221, a13
    v_accvgpr_read_b32 v222, a14
    v_accvgpr_read_b32 v223, a15
    v_exp_f32_e64 v124, v124
    v_pk_mul_f32 v[220:221], v[220:221], v[28:29] op_sel_hi:[1,0]
    v_pk_mul_f32 v[222:223], v[222:223], v[28:29] op_sel_hi:[1,0]
    v_cvt_pk_bf16_f32 v220, v220, v221
    v_exp_f32_e64 v125, v125
    v_cvt_pk_bf16_f32 v221, v222, v223
    ds_write_b64 v35, v[220:221] offset:0
    v_mfma_f32_16x16x32_bf16 v[156:159], v[188:191], a[196:199], v[156:159]
    v_add_f32_e64 v20, v20, v124
    ds_read_b128 v[96:99], v36 offset:0
    v_mfma_f32_16x16x32_bf16 v[156:159], a[248:251], a[200:203], v[156:159]
    ds_read_b128 v[100:103], v36 offset:12288
    v_add_f32_e64 v20, v20, v125
    v_cvt_pk_bf16_f32 v122, v124, v125
    v_mfma_f32_16x16x32_bf16 v[156:159], a[252:255], a[204:207], v[156:159]
    v_exp_f32 v126, v126
    v_exp_f32 v127, v127
    v_mfma_f32_16x16x32_bf16 v[156:159], a[216:219], a[208:211], v[156:159]
    v_accvgpr_read_b32 v224, a16
    v_accvgpr_read_b32 v225, a17
    v_accvgpr_read_b32 v226, a18
    v_add_f32_e64 v20, v20, v126
    v_accvgpr_read_b32 v227, a19
    v_pk_mul_f32 v[224:225], v[224:225], v[28:29] op_sel_hi:[1,0]
    v_mfma_f32_16x16x32_bf16 v[156:159], a[220:223], a[212:215], v[156:159]
    v_pk_mul_f32 v[226:227], v[226:227], v[28:29] op_sel_hi:[1,0]
    v_cvt_pk_bf16_f32 v224, v224, v225
    v_cvt_pk_bf16_f32 v225, v226, v227
    v_add_f32_e64 v20, v20, v127
    ds_write_b64 v32, v[224:225] offset:128
    v_cvt_pk_bf16_f32 v123, v126, v127
    v_accvgpr_read_b32 v228, a20
    v_exp_f32 v152, v152
    s_waitcnt lgkmcnt(1)
    buffer_store_dwordx4 v[96:99], v37, s[28:31], s65 offen offset:0 sc1
    buffer_store_dwordx4 v[100:103], v37, s[28:31], s65 offen offset:3072 sc1
    v_mfma_f32_16x16x32_bf16 a[48:51], a[224:227], v[120:123], a[48:51]
    v_accvgpr_read_b32 v229, a21
    v_accvgpr_read_b32 v230, a22
    v_accvgpr_read_b32 v231, a23
    v_exp_f32_e64 v153, v153
    v_pk_mul_f32 v[228:229], v[228:229], v[28:29] op_sel_hi:[1,0]
    v_pk_mul_f32 v[230:231], v[230:231], v[28:29] op_sel_hi:[1,0]
    v_cvt_pk_bf16_f32 v228, v228, v229
    v_mfma_f32_16x16x32_bf16 a[52:55], a[228:231], v[120:123], a[52:55]
    v_cvt_pk_bf16_f32 v229, v230, v231
    ds_write_b64 v33, v[228:229] offset:128
    v_add_f32_e64 v20, v20, v152
    v_mfma_f32_16x16x32_bf16 a[56:59], a[232:235], v[120:123], a[56:59]
    v_accvgpr_read_b32 v232, a24
    v_add_f32_e64 v20, v20, v153
    v_accvgpr_read_b32 v233, a25
    v_accvgpr_read_b32 v234, a26
    v_cvt_pk_bf16_f32 v152, v152, v153
    v_accvgpr_read_b32 v235, a27
    v_mfma_f32_16x16x32_bf16 a[60:63], a[236:239], v[120:123], a[60:63]
    v_pk_mul_f32 v[232:233], v[232:233], v[28:29] op_sel_hi:[1,0]
    v_pk_mul_f32 v[234:235], v[234:235], v[28:29] op_sel_hi:[1,0]
    v_cvt_pk_bf16_f32 v232, v232, v233
    v_exp_f32_e64 v154, v154
    v_cvt_pk_bf16_f32 v233, v234, v235
    ds_write_b64 v34, v[232:233] offset:128
    v_exp_f32_e64 v155, v155
    v_mfma_f32_16x16x32_bf16 a[64:67], v[44:47], v[120:123], a[64:67]
    v_accvgpr_read_b32 v236, a28
    v_accvgpr_read_b32 v237, a29
    v_accvgpr_read_b32 v238, a30
    v_add_f32_e64 v20, v20, v154
    v_accvgpr_read_b32 v239, a31
    v_pk_mul_f32 v[236:237], v[236:237], v[28:29] op_sel_hi:[1,0]
    v_mfma_f32_16x16x32_bf16 a[68:71], v[48:51], v[120:123], a[68:71]
    v_pk_mul_f32 v[238:239], v[238:239], v[28:29] op_sel_hi:[1,0]
    v_cvt_pk_bf16_f32 v236, v236, v237
    v_cvt_pk_bf16_f32 v237, v238, v239
    v_add_f32_e64 v20, v20, v155
    ds_write_b64 v35, v[236:237] offset:128
    v_cvt_pk_bf16_f32 v153, v154, v155
    v_mfma_f32_16x16x32_bf16 a[72:75], v[52:55], v[120:123], a[72:75]
    ds_read_b128 v[104:107], v36 offset:128
    v_exp_f32_e64 v156, v156
    ds_read_b128 v[108:111], v36 offset:12416
    v_exp_f32_e64 v157, v157
    v_mfma_f32_16x16x32_bf16 a[76:79], v[56:59], v[120:123], a[76:79]
    v_add_f32 v20, v20, v156
    v_add_f32 v20, v20, v157
    v_mfma_f32_16x16x32_bf16 a[80:83], v[60:63], v[120:123], a[80:83]
    v_cvt_pk_bf16_f32 v154, v156, v157
    v_accvgpr_read_b32 v240, a32
    v_mfma_f32_16x16x32_bf16 a[84:87], v[64:67], v[120:123], a[84:87]
    v_accvgpr_read_b32 v241, a33
    v_accvgpr_read_b32 v242, a34
    v_accvgpr_read_b32 v243, a35
    v_exp_f32_e64 v158, v158
    v_pk_mul_f32 v[240:241], v[240:241], v[28:29] op_sel_hi:[1,0]
    v_pk_mul_f32 v[242:243], v[242:243], v[28:29] op_sel_hi:[1,0]
    v_cvt_pk_bf16_f32 v240, v240, v241
    v_exp_f32_e64 v159, v159
    v_cvt_pk_bf16_f32 v241, v242, v243
    ds_write_b64 v32, v[240:241] offset:256
    v_mfma_f32_16x16x32_bf16 a[88:91], a[240:243], v[120:123], a[88:91]
    v_add_f32 v20, v20, v158
    s_waitcnt lgkmcnt(1)
    buffer_store_dwordx4 v[104:107], v37, s[28:31], s65 offen offset:128 sc1
    buffer_store_dwordx4 v[108:111], v37, s[28:31], s65 offen offset:3200 sc1
    v_accvgpr_read_b32 v244, a36
    v_accvgpr_read_b32 v245, a37
    v_mfma_f32_16x16x32_bf16 a[92:95], a[244:247], v[120:123], a[92:95]
    v_accvgpr_read_b32 v246, a38
    v_accvgpr_read_b32 v247, a39
    v_pk_mul_f32 v[244:245], v[244:245], v[28:29] op_sel_hi:[1,0]
    v_add_f32_e64 v20, v20, v159
    v_pk_mul_f32 v[246:247], v[246:247], v[28:29] op_sel_hi:[1,0]
    v_cvt_pk_bf16_f32 v155, v158, v159
    v_cvt_pk_bf16_f32 v244, v244, v245
    v_cvt_pk_bf16_f32 v245, v246, v247
    v_mov_b32_e64 v39, v20
    ds_write_b64 v33, v[244:245] offset:256
    s_nop 0
    v_permlane16_swap_b32 v20, v39
    v_add_f32 v20, v20, v39
    v_mov_b32 v39, v20
    v_accvgpr_read_b32 v248, a40
    v_accvgpr_read_b32 v249, a41
    v_permlane32_swap_b32 v20, v39
    v_add_f32 v20, v20, v39
    v_accvgpr_read_b32 v250, a42
    v_accvgpr_read_b32 v251, a43
    v_rcp_f32_e64 v38, v20
    v_pk_mul_f32 v[248:249], v[248:249], v[28:29] op_sel_hi:[1,0]
    v_pk_mul_f32 v[250:251], v[250:251], v[28:29] op_sel_hi:[1,0]
    v_cvt_pk_bf16_f32 v248, v248, v249
    v_mfma_f32_16x16x32_bf16 a[48:51], a[120:123], v[152:155], a[48:51]
    v_cvt_pk_bf16_f32 v249, v250, v251
    ds_write_b64 v34, v[248:249] offset:256
    v_mfma_f32_16x16x32_bf16 a[52:55], a[124:127], v[152:155], a[52:55]
    v_accvgpr_read_b32 v252, a44
    v_accvgpr_read_b32 v253, a45
    v_mfma_f32_16x16x32_bf16 a[56:59], a[128:131], v[152:155], a[56:59]
    v_accvgpr_read_b32 v254, a46
    v_accvgpr_read_b32 v255, a47
    v_mfma_f32_16x16x32_bf16 a[60:63], a[132:135], v[152:155], a[60:63]
    v_pk_mul_f32 v[252:253], v[252:253], v[28:29] op_sel_hi:[1,0]
    v_pk_mul_f32 v[254:255], v[254:255], v[28:29] op_sel_hi:[1,0]
    v_mfma_f32_16x16x32_bf16 a[64:67], a[136:139], v[152:155], a[64:67]
    v_cvt_pk_bf16_f32 v252, v252, v253
    v_cvt_pk_bf16_f32 v253, v254, v255
    ds_write_b64 v35, v[252:253] offset:256
    v_mfma_f32_16x16x32_bf16 a[68:71], a[140:143], v[152:155], a[68:71]
    ds_read_b128 v[96:99], v36 offset:256
    ds_read_b128 v[100:103], v36 offset:12544
    v_mfma_f32_16x16x32_bf16 a[72:75], a[144:147], v[152:155], a[72:75]
    v_add_f32 v88, v17, v18
    v_add_f32 v89, v19, v20
    v_mfma_f32_16x16x32_bf16 a[76:79], a[148:151], v[152:155], a[76:79]
    v_add_f32 v88, v88, v21
    v_add_f32 v88, v88, v89
    v_mfma_f32_16x16x32_bf16 a[80:83], a[152:155], v[152:155], a[80:83]
    v_cmp_nge_f32 vcc, s48, v88
    v_lshlrev_b32 v89, 4, v0
    v_mfma_f32_16x16x32_bf16 a[84:87], a[156:159], v[152:155], a[84:87]
    v_cndmask_b32_e64 v88, 0, 1, vcc
    ds_write_b32 v41, v88 offset:1024
    v_mfma_f32_16x16x32_bf16 a[88:91], a[160:163], v[152:155], a[88:91]
    v_add_u32 v89, 148480, v89
    v_accvgpr_read_b32 v160, a48
    v_mfma_f32_16x16x32_bf16 a[92:95], a[164:167], v[152:155], a[92:95]
    v_accvgpr_read_b32 v161, a49
    v_accvgpr_read_b32 v162, a50
    v_accvgpr_read_b32 v163, a51
    v_pk_mul_f32 v[160:161], v[160:161], v[38:39] op_sel_hi:[1,0]
    v_pk_mul_f32 v[162:163], v[162:163], v[38:39] op_sel_hi:[1,0]
    v_cvt_pk_bf16_f32 v160, v160, v161
    v_cvt_pk_bf16_f32 v161, v162, v163
    ds_write_b64 v32, v[160:161] offset:0
    s_waitcnt lgkmcnt(2)
    buffer_store_dwordx4 v[96:99], v37, s[28:31], s65 offen offset:256 sc1
    buffer_store_dwordx4 v[100:103], v37, s[28:31], s65 offen offset:3328 sc1
    v_accvgpr_read_b32 v164, a52
    v_accvgpr_read_b32 v165, a53
    v_accvgpr_read_b32 v166, a54
    v_accvgpr_read_b32 v167, a55
    v_pk_mul_f32 v[164:165], v[164:165], v[38:39] op_sel_hi:[1,0]
    v_pk_mul_f32 v[166:167], v[166:167], v[38:39] op_sel_hi:[1,0]
    v_cvt_pk_bf16_f32 v164, v164, v165
    v_cvt_pk_bf16_f32 v165, v166, v167
    ds_write_b64 v33, v[164:165] offset:0
    v_accvgpr_read_b32 v168, a56
    v_accvgpr_read_b32 v169, a57
    v_accvgpr_read_b32 v170, a58
    v_accvgpr_read_b32 v171, a59
    v_pk_mul_f32 v[168:169], v[168:169], v[38:39] op_sel_hi:[1,0]
    v_pk_mul_f32 v[170:171], v[170:171], v[38:39] op_sel_hi:[1,0]
    v_cvt_pk_bf16_f32 v168, v168, v169
    v_cvt_pk_bf16_f32 v169, v170, v171
    ds_write_b64 v34, v[168:169] offset:0
    v_accvgpr_read_b32 v172, a60
    v_accvgpr_read_b32 v173, a61
    v_accvgpr_read_b32 v174, a62
    v_accvgpr_read_b32 v175, a63
    v_pk_mul_f32 v[172:173], v[172:173], v[38:39] op_sel_hi:[1,0]
    v_pk_mul_f32 v[174:175], v[174:175], v[38:39] op_sel_hi:[1,0]
    v_cvt_pk_bf16_f32 v172, v172, v173
    v_cvt_pk_bf16_f32 v173, v174, v175
    ds_write_b64 v35, v[172:173] offset:0
    ds_read_b128 v[104:107], v36 offset:0
    ds_read_b128 v[108:111], v36 offset:12288
    v_accvgpr_read_b32 v176, a64
    v_accvgpr_read_b32 v177, a65
    v_accvgpr_read_b32 v178, a66
    v_accvgpr_read_b32 v179, a67
    v_pk_mul_f32 v[176:177], v[176:177], v[38:39] op_sel_hi:[1,0]
    v_pk_mul_f32 v[178:179], v[178:179], v[38:39] op_sel_hi:[1,0]
    v_cvt_pk_bf16_f32 v176, v176, v177
    v_cvt_pk_bf16_f32 v177, v178, v179
    ds_write_b64 v32, v[176:177] offset:128
    v_accvgpr_read_b32 v180, a68
    v_accvgpr_read_b32 v181, a69
    v_accvgpr_read_b32 v182, a70
    v_accvgpr_read_b32 v183, a71
    v_pk_mul_f32 v[180:181], v[180:181], v[38:39] op_sel_hi:[1,0]
    v_pk_mul_f32 v[182:183], v[182:183], v[38:39] op_sel_hi:[1,0]
    v_cvt_pk_bf16_f32 v180, v180, v181
    v_cvt_pk_bf16_f32 v181, v182, v183
    ds_write_b64 v33, v[180:181] offset:128
    v_accvgpr_read_b32 v184, a72
    v_accvgpr_read_b32 v185, a73
    v_accvgpr_read_b32 v186, a74
    v_accvgpr_read_b32 v187, a75
    v_pk_mul_f32 v[184:185], v[184:185], v[38:39] op_sel_hi:[1,0]
    v_pk_mul_f32 v[186:187], v[186:187], v[38:39] op_sel_hi:[1,0]
    s_waitcnt lgkmcnt(2)
    buffer_store_dwordx4 v[104:107], v37, s[28:31], s66 offen offset:0 sc1
    buffer_store_dwordx4 v[108:111], v37, s[28:31], s66 offen offset:3072 sc1
    v_cvt_pk_bf16_f32 v184, v184, v185
    v_cvt_pk_bf16_f32 v185, v186, v187
    ds_write_b64 v34, v[184:185] offset:128
    v_accvgpr_read_b32 v188, a76
    v_accvgpr_read_b32 v189, a77
    v_accvgpr_read_b32 v190, a78
    v_accvgpr_read_b32 v191, a79
    v_pk_mul_f32 v[188:189], v[188:189], v[38:39] op_sel_hi:[1,0]
    v_pk_mul_f32 v[190:191], v[190:191], v[38:39] op_sel_hi:[1,0]
    v_cvt_pk_bf16_f32 v188, v188, v189
    v_cvt_pk_bf16_f32 v189, v190, v191
    ds_write_b64 v35, v[188:189] offset:128
    ds_read_b128 v[96:99], v36 offset:128
    ds_read_b128 v[100:103], v36 offset:12416
    v_accvgpr_read_b32 v192, a80
    v_accvgpr_read_b32 v193, a81
    v_accvgpr_read_b32 v194, a82
    v_accvgpr_read_b32 v195, a83
    v_pk_mul_f32 v[192:193], v[192:193], v[38:39] op_sel_hi:[1,0]
    v_pk_mul_f32 v[194:195], v[194:195], v[38:39] op_sel_hi:[1,0]
    v_cvt_pk_bf16_f32 v192, v192, v193
    v_cvt_pk_bf16_f32 v193, v194, v195
    ds_write_b64 v32, v[192:193] offset:256
    v_accvgpr_read_b32 v196, a84
    v_accvgpr_read_b32 v197, a85
    v_accvgpr_read_b32 v198, a86
    v_accvgpr_read_b32 v199, a87
    v_pk_mul_f32 v[196:197], v[196:197], v[38:39] op_sel_hi:[1,0]
    v_pk_mul_f32 v[198:199], v[198:199], v[38:39] op_sel_hi:[1,0]
    v_cvt_pk_bf16_f32 v196, v196, v197
    v_cvt_pk_bf16_f32 v197, v198, v199
    ds_write_b64 v33, v[196:197] offset:256
    v_accvgpr_read_b32 v200, a88
    v_accvgpr_read_b32 v201, a89
    v_accvgpr_read_b32 v202, a90
    v_accvgpr_read_b32 v203, a91
    v_pk_mul_f32 v[200:201], v[200:201], v[38:39] op_sel_hi:[1,0]
    v_pk_mul_f32 v[202:203], v[202:203], v[38:39] op_sel_hi:[1,0]
    s_waitcnt lgkmcnt(2)
    buffer_store_dwordx4 v[96:99], v37, s[28:31], s66 offen offset:128 sc1
    buffer_store_dwordx4 v[100:103], v37, s[28:31], s66 offen offset:3200 sc1
    v_cvt_pk_bf16_f32 v200, v200, v201
    v_cvt_pk_bf16_f32 v201, v202, v203
    ds_write_b64 v34, v[200:201] offset:256
    v_accvgpr_read_b32 v204, a92
    v_accvgpr_read_b32 v205, a93
    v_accvgpr_read_b32 v206, a94
    v_accvgpr_read_b32 v207, a95
    v_pk_mul_f32 v[204:205], v[204:205], v[38:39] op_sel_hi:[1,0]
    v_pk_mul_f32 v[206:207], v[206:207], v[38:39] op_sel_hi:[1,0]
    v_cvt_pk_bf16_f32 v204, v204, v205
    v_cvt_pk_bf16_f32 v205, v206, v207
    ds_write_b64 v35, v[204:205] offset:256
    ds_read_b128 v[104:107], v36 offset:256
    ds_read_b128 v[108:111], v36 offset:12544
    s_waitcnt lgkmcnt(1)
    buffer_store_dwordx4 v[104:107], v37, s[28:31], s66 offen offset:256 sc1
    s_waitcnt lgkmcnt(0)
    buffer_store_dwordx4 v[108:111], v37, s[28:31], s66 offen offset:3328 sc1
    s_waitcnt lgkmcnt(0)
    s_barrier
    ds_read_b128 v[144:147], v89 offset:0
    s_cmp_lg_u32 s47, 0
    s_cbranch_scc1 L_done
    s_waitcnt lgkmcnt(0)
    v_or3_b32 v88, v144, v145, v146
    v_or_b32 v88, v88, v147
    v_cmp_ne_u32 vcc, 0, v88
    s_nop 1
    s_cbranch_vccnz L_fallback
L_done:
L_end:
    s_endpgm
L_fallback:
    s_mov_b32 s47, 1
    s_waitcnt vmcnt(0) lgkmcnt(0)
    s_barrier
    s_mov_b32 m0, s40
    s_mov_b32 s54, 0
    buffer_load_dwordx4 v11, s[20:23], s54 offen offset:0 nt lds
    buffer_load_dwordx4 v12, s[20:23], s54 offen offset:1024 nt lds
    buffer_load_dwordx4 v13, s[20:23], s54 offen offset:2048 nt lds
    s_add_u32 m0, s40, 12288
    s_mov_b32 s54, 0
    buffer_load_dwordx4 v14, s[24:27], s54 offen offset:0 nt lds
    buffer_load_dwordx4 v15, s[24:27], s54 offen offset:1024 nt lds
    buffer_load_dwordx4 v16, s[24:27], s54 offen offset:2048 nt lds
    s_add_u32 m0, s40, 24576
    s_mov_b32 s54, 12288
    buffer_load_dwordx4 v11, s[20:23], s54 offen offset:0 nt lds
    buffer_load_dwordx4 v12, s[20:23], s54 offen offset:1024 nt lds
    buffer_load_dwordx4 v13, s[20:23], s54 offen offset:2048 nt lds
    s_add_u32 m0, s40, 36864
    s_mov_b32 s54, 12288
    buffer_load_dwordx4 v14, s[24:27], s54 offen offset:0 nt lds
    buffer_load_dwordx4 v15, s[24:27], s54 offen offset:1024 nt lds
    buffer_load_dwordx4 v16, s[24:27], s54 offen offset:2048 nt lds
    s_add_u32 m0, s40, 49152
    s_mov_b32 s54, 24576
    buffer_load_dwordx4 v11, s[20:23], s54 offen offset:0 nt lds
    buffer_load_dwordx4 v12, s[20:23], s54 offen offset:1024 nt lds
    buffer_load_dwordx4 v13, s[20:23], s54 offen offset:2048 nt lds
    s_add_u32 m0, s40, 61440
    s_mov_b32 s54, 24576
    buffer_load_dwordx4 v14, s[24:27], s54 offen offset:0 nt lds
    buffer_load_dwordx4 v15, s[24:27], s54 offen offset:1024 nt lds
    buffer_load_dwordx4 v16, s[24:27], s54 offen offset:2048 nt lds
    v_and_b32 v26, 15, v0
    v_mul_u32_u24 v26, 384, v26
    v_lshrrev_b32 v25, 4, v0
    v_lshl_add_u32 v26, v25, 4, v26
    v_add_u32 v26, 2048, v26
    s_mul_i32 s55, s3, 24576
    s_add_u32 s55, s55, 0
    buffer_load_dwordx4 v[160:163], v26, s[16:19], s55 offen offset:0
    buffer_load_dwordx4 v[164:167], v26, s[16:19], s55 offen offset:64
    buffer_load_dwordx4 v[168:171], v26, s[16:19], s55 offen offset:128
    buffer_load_dwordx4 v[172:175], v26, s[16:19], s55 offen offset:192
    buffer_load_dwordx4 v[176:179], v26, s[16:19], s55 offen offset:256
    buffer_load_dwordx4 v[180:183], v26, s[16:19], s55 offen offset:320
    s_waitcnt vmcnt(0)
    v_lshlrev_b32 v24, 16, v160
    v_and_b32 v25, 4294901760, v160
    v_mul_f32 v24, s52, v24
    v_mul_f32 v25, s52, v25
    v_cvt_pk_bf16_f32 v160, v24, v25
    v_accvgpr_write_b32 a120, v160
    v_lshlrev_b32 v24, 16, v161
    v_and_b32 v25, 4294901760, v161
    v_mul_f32 v24, s52, v24
    v_mul_f32 v25, s52, v25
    v_cvt_pk_bf16_f32 v161, v24, v25
    v_accvgpr_write_b32 a121, v161
    v_lshlrev_b32 v24, 16, v162
    v_and_b32 v25, 4294901760, v162
    v_mul_f32 v24, s52, v24
    v_mul_f32 v25, s52, v25
    v_cvt_pk_bf16_f32 v162, v24, v25
    v_accvgpr_write_b32 a122, v162
    v_lshlrev_b32 v24, 16, v163
    v_and_b32 v25, 4294901760, v163
    v_mul_f32 v24, s52, v24
    v_mul_f32 v25, s52, v25
    v_cvt_pk_bf16_f32 v163, v24, v25
    v_accvgpr_write_b32 a123, v163
    v_lshlrev_b32 v24, 16, v164
    v_and_b32 v25, 4294901760, v164
    v_mul_f32 v24, s52, v24
    v_mul_f32 v25, s52, v25
    v_cvt_pk_bf16_f32 v164, v24, v25
    v_accvgpr_write_b32 a124, v164
    v_lshlrev_b32 v24, 16, v165
    v_and_b32 v25, 4294901760, v165
    v_mul_f32 v24, s52, v24
    v_mul_f32 v25, s52, v25
    v_cvt_pk_bf16_f32 v165, v24, v25
    v_accvgpr_write_b32 a125, v165
    v_lshlrev_b32 v24, 16, v166
    v_and_b32 v25, 4294901760, v166
    v_mul_f32 v24, s52, v24
    v_mul_f32 v25, s52, v25
    v_cvt_pk_bf16_f32 v166, v24, v25
    v_accvgpr_write_b32 a126, v166
    v_lshlrev_b32 v24, 16, v167
    v_and_b32 v25, 4294901760, v167
    v_mul_f32 v24, s52, v24
    v_mul_f32 v25, s52, v25
    v_cvt_pk_bf16_f32 v167, v24, v25
    v_accvgpr_write_b32 a127, v167
    v_lshlrev_b32 v24, 16, v168
    v_and_b32 v25, 4294901760, v168
    v_mul_f32 v24, s52, v24
    v_mul_f32 v25, s52, v25
    v_cvt_pk_bf16_f32 v168, v24, v25
    v_accvgpr_write_b32 a128, v168
    v_lshlrev_b32 v24, 16, v169
    v_and_b32 v25, 4294901760, v169
    v_mul_f32 v24, s52, v24
    v_mul_f32 v25, s52, v25
    v_cvt_pk_bf16_f32 v169, v24, v25
    v_accvgpr_write_b32 a129, v169
    v_lshlrev_b32 v24, 16, v170
    v_and_b32 v25, 4294901760, v170
    v_mul_f32 v24, s52, v24
    v_mul_f32 v25, s52, v25
    v_cvt_pk_bf16_f32 v170, v24, v25
    v_accvgpr_write_b32 a130, v170
    v_lshlrev_b32 v24, 16, v171
    v_and_b32 v25, 4294901760, v171
    v_mul_f32 v24, s52, v24
    v_mul_f32 v25, s52, v25
    v_cvt_pk_bf16_f32 v171, v24, v25
    v_accvgpr_write_b32 a131, v171
    v_lshlrev_b32 v24, 16, v172
    v_and_b32 v25, 4294901760, v172
    v_mul_f32 v24, s52, v24
    v_mul_f32 v25, s52, v25
    v_cvt_pk_bf16_f32 v172, v24, v25
    v_accvgpr_write_b32 a132, v172
    v_lshlrev_b32 v24, 16, v173
    v_and_b32 v25, 4294901760, v173
    v_mul_f32 v24, s52, v24
    v_mul_f32 v25, s52, v25
    v_cvt_pk_bf16_f32 v173, v24, v25
    v_accvgpr_write_b32 a133, v173
    v_lshlrev_b32 v24, 16, v174
    v_and_b32 v25, 4294901760, v174
    v_mul_f32 v24, s52, v24
    v_mul_f32 v25, s52, v25
    v_cvt_pk_bf16_f32 v174, v24, v25
    v_accvgpr_write_b32 a134, v174
    v_lshlrev_b32 v24, 16, v175
    v_and_b32 v25, 4294901760, v175
    v_mul_f32 v24, s52, v24
    v_mul_f32 v25, s52, v25
    v_cvt_pk_bf16_f32 v175, v24, v25
    v_accvgpr_write_b32 a135, v175
    v_lshlrev_b32 v24, 16, v176
    v_and_b32 v25, 4294901760, v176
    v_mul_f32 v24, s52, v24
    v_mul_f32 v25, s52, v25
    v_cvt_pk_bf16_f32 v176, v24, v25
    v_accvgpr_write_b32 a136, v176
    v_lshlrev_b32 v24, 16, v177
    v_and_b32 v25, 4294901760, v177
    v_mul_f32 v24, s52, v24
    v_mul_f32 v25, s52, v25
    v_cvt_pk_bf16_f32 v177, v24, v25
    v_accvgpr_write_b32 a137, v177
    v_lshlrev_b32 v24, 16, v178
    v_and_b32 v25, 4294901760, v178
    v_mul_f32 v24, s52, v24
    v_mul_f32 v25, s52, v25
    v_cvt_pk_bf16_f32 v178, v24, v25
    v_accvgpr_write_b32 a138, v178
    v_lshlrev_b32 v24, 16, v179
    v_and_b32 v25, 4294901760, v179
    v_mul_f32 v24, s52, v24
    v_mul_f32 v25, s52, v25
    v_cvt_pk_bf16_f32 v179, v24, v25
    v_accvgpr_write_b32 a139, v179
    v_lshlrev_b32 v24, 16, v180
    v_and_b32 v25, 4294901760, v180
    v_mul_f32 v24, s52, v24
    v_mul_f32 v25, s52, v25
    v_cvt_pk_bf16_f32 v180, v24, v25
    v_accvgpr_write_b32 a140, v180
    v_lshlrev_b32 v24, 16, v181
    v_and_b32 v25, 4294901760, v181
    v_mul_f32 v24, s52, v24
    v_mul_f32 v25, s52, v25
    v_cvt_pk_bf16_f32 v181, v24, v25
    v_accvgpr_write_b32 a141, v181
    v_lshlrev_b32 v24, 16, v182
    v_and_b32 v25, 4294901760, v182
    v_mul_f32 v24, s52, v24
    v_mul_f32 v25, s52, v25
    v_cvt_pk_bf16_f32 v182, v24, v25
    v_accvgpr_write_b32 a142, v182
    v_lshlrev_b32 v24, 16, v183
    v_and_b32 v25, 4294901760, v183
    v_mul_f32 v24, s52, v24
    v_mul_f32 v25, s52, v25
    v_cvt_pk_bf16_f32 v183, v24, v25
    v_accvgpr_write_b32 a143, v183
    s_mul_i32 s55, s3, 24576
    s_add_u32 s55, s55, 6144
    buffer_load_dwordx4 v[160:163], v26, s[16:19], s55 offen offset:0
    buffer_load_dwordx4 v[164:167], v26, s[16:19], s55 offen offset:64
    buffer_load_dwordx4 v[168:171], v26, s[16:19], s55 offen offset:128
    buffer_load_dwordx4 v[172:175], v26, s[16:19], s55 offen offset:192
    buffer_load_dwordx4 v[176:179], v26, s[16:19], s55 offen offset:256
    buffer_load_dwordx4 v[180:183], v26, s[16:19], s55 offen offset:320
    s_waitcnt vmcnt(0)
    v_lshlrev_b32 v24, 16, v160
    v_and_b32 v25, 4294901760, v160
    v_mul_f32 v24, s52, v24
    v_mul_f32 v25, s52, v25
    v_cvt_pk_bf16_f32 v160, v24, v25
    v_accvgpr_write_b32 a144, v160
    v_lshlrev_b32 v24, 16, v161
    v_and_b32 v25, 4294901760, v161
    v_mul_f32 v24, s52, v24
    v_mul_f32 v25, s52, v25
    v_cvt_pk_bf16_f32 v161, v24, v25
    v_accvgpr_write_b32 a145, v161
    v_lshlrev_b32 v24, 16, v162
    v_and_b32 v25, 4294901760, v162
    v_mul_f32 v24, s52, v24
    v_mul_f32 v25, s52, v25
    v_cvt_pk_bf16_f32 v162, v24, v25
    v_accvgpr_write_b32 a146, v162
    v_lshlrev_b32 v24, 16, v163
    v_and_b32 v25, 4294901760, v163
    v_mul_f32 v24, s52, v24
    v_mul_f32 v25, s52, v25
    v_cvt_pk_bf16_f32 v163, v24, v25
    v_accvgpr_write_b32 a147, v163
    v_lshlrev_b32 v24, 16, v164
    v_and_b32 v25, 4294901760, v164
    v_mul_f32 v24, s52, v24
    v_mul_f32 v25, s52, v25
    v_cvt_pk_bf16_f32 v164, v24, v25
    v_accvgpr_write_b32 a148, v164
    v_lshlrev_b32 v24, 16, v165
    v_and_b32 v25, 4294901760, v165
    v_mul_f32 v24, s52, v24
    v_mul_f32 v25, s52, v25
    v_cvt_pk_bf16_f32 v165, v24, v25
    v_accvgpr_write_b32 a149, v165
    v_lshlrev_b32 v24, 16, v166
    v_and_b32 v25, 4294901760, v166
    v_mul_f32 v24, s52, v24
    v_mul_f32 v25, s52, v25
    v_cvt_pk_bf16_f32 v166, v24, v25
    v_accvgpr_write_b32 a150, v166
    v_lshlrev_b32 v24, 16, v167
    v_and_b32 v25, 4294901760, v167
    v_mul_f32 v24, s52, v24
    v_mul_f32 v25, s52, v25
    v_cvt_pk_bf16_f32 v167, v24, v25
    v_accvgpr_write_b32 a151, v167
    v_lshlrev_b32 v24, 16, v168
    v_and_b32 v25, 4294901760, v168
    v_mul_f32 v24, s52, v24
    v_mul_f32 v25, s52, v25
    v_cvt_pk_bf16_f32 v168, v24, v25
    v_accvgpr_write_b32 a152, v168
    v_lshlrev_b32 v24, 16, v169
    v_and_b32 v25, 4294901760, v169
    v_mul_f32 v24, s52, v24
    v_mul_f32 v25, s52, v25
    v_cvt_pk_bf16_f32 v169, v24, v25
    v_accvgpr_write_b32 a153, v169
    v_lshlrev_b32 v24, 16, v170
    v_and_b32 v25, 4294901760, v170
    v_mul_f32 v24, s52, v24
    v_mul_f32 v25, s52, v25
    v_cvt_pk_bf16_f32 v170, v24, v25
    v_accvgpr_write_b32 a154, v170
    v_lshlrev_b32 v24, 16, v171
    v_and_b32 v25, 4294901760, v171
    v_mul_f32 v24, s52, v24
    v_mul_f32 v25, s52, v25
    v_cvt_pk_bf16_f32 v171, v24, v25
    v_accvgpr_write_b32 a155, v171
    v_lshlrev_b32 v24, 16, v172
    v_and_b32 v25, 4294901760, v172
    v_mul_f32 v24, s52, v24
    v_mul_f32 v25, s52, v25
    v_cvt_pk_bf16_f32 v172, v24, v25
    v_accvgpr_write_b32 a156, v172
    v_lshlrev_b32 v24, 16, v173
    v_and_b32 v25, 4294901760, v173
    v_mul_f32 v24, s52, v24
    v_mul_f32 v25, s52, v25
    v_cvt_pk_bf16_f32 v173, v24, v25
    v_accvgpr_write_b32 a157, v173
    v_lshlrev_b32 v24, 16, v174
    v_and_b32 v25, 4294901760, v174
    v_mul_f32 v24, s52, v24
    v_mul_f32 v25, s52, v25
    v_cvt_pk_bf16_f32 v174, v24, v25
    v_accvgpr_write_b32 a158, v174
    v_lshlrev_b32 v24, 16, v175
    v_and_b32 v25, 4294901760, v175
    v_mul_f32 v24, s52, v24
    v_mul_f32 v25, s52, v25
    v_cvt_pk_bf16_f32 v175, v24, v25
    v_accvgpr_write_b32 a159, v175
    v_lshlrev_b32 v24, 16, v176
    v_and_b32 v25, 4294901760, v176
    v_mul_f32 v24, s52, v24
    v_mul_f32 v25, s52, v25
    v_cvt_pk_bf16_f32 v176, v24, v25
    v_accvgpr_write_b32 a160, v176
    v_lshlrev_b32 v24, 16, v177
    v_and_b32 v25, 4294901760, v177
    v_mul_f32 v24, s52, v24
    v_mul_f32 v25, s52, v25
    v_cvt_pk_bf16_f32 v177, v24, v25
    v_accvgpr_write_b32 a161, v177
    v_lshlrev_b32 v24, 16, v178
    v_and_b32 v25, 4294901760, v178
    v_mul_f32 v24, s52, v24
    v_mul_f32 v25, s52, v25
    v_cvt_pk_bf16_f32 v178, v24, v25
    v_accvgpr_write_b32 a162, v178
    v_lshlrev_b32 v24, 16, v179
    v_and_b32 v25, 4294901760, v179
    v_mul_f32 v24, s52, v24
    v_mul_f32 v25, s52, v25
    v_cvt_pk_bf16_f32 v179, v24, v25
    v_accvgpr_write_b32 a163, v179
    v_lshlrev_b32 v24, 16, v180
    v_and_b32 v25, 4294901760, v180
    v_mul_f32 v24, s52, v24
    v_mul_f32 v25, s52, v25
    v_cvt_pk_bf16_f32 v180, v24, v25
    v_accvgpr_write_b32 a164, v180
    v_lshlrev_b32 v24, 16, v181
    v_and_b32 v25, 4294901760, v181
    v_mul_f32 v24, s52, v24
    v_mul_f32 v25, s52, v25
    v_cvt_pk_bf16_f32 v181, v24, v25
    v_accvgpr_write_b32 a165, v181
    v_lshlrev_b32 v24, 16, v182
    v_and_b32 v25, 4294901760, v182
    v_mul_f32 v24, s52, v24
    v_mul_f32 v25, s52, v25
    v_cvt_pk_bf16_f32 v182, v24, v25
    v_accvgpr_write_b32 a166, v182
    v_lshlrev_b32 v24, 16, v183
    v_and_b32 v25, 4294901760, v183
    v_mul_f32 v24, s52, v24
    v_mul_f32 v25, s52, v25
    v_cvt_pk_bf16_f32 v183, v24, v25
    v_accvgpr_write_b32 a167, v183
    s_mul_i32 s55, s49, 6144
    s_add_u32 s55, s55, 98304
    buffer_load_dwordx4 v[160:163], v26, s[16:19], s55 offen offset:0
    buffer_load_dwordx4 v[164:167], v26, s[16:19], s55 offen offset:64
    buffer_load_dwordx4 v[168:171], v26, s[16:19], s55 offen offset:128
    buffer_load_dwordx4 v[172:175], v26, s[16:19], s55 offen offset:192
    buffer_load_dwordx4 v[176:179], v26, s[16:19], s55 offen offset:256
    buffer_load_dwordx4 v[180:183], v26, s[16:19], s55 offen offset:320
    s_waitcnt vmcnt(0)
    v_lshlrev_b32 v24, 16, v160
    v_and_b32 v25, 4294901760, v160
    v_mul_f32 v24, s52, v24
    v_mul_f32 v25, s52, v25
    v_cvt_pk_bf16_f32 v160, v24, v25
    v_accvgpr_write_b32 a216, v160
    v_lshlrev_b32 v24, 16, v161
    v_and_b32 v25, 4294901760, v161
    v_mul_f32 v24, s52, v24
    v_mul_f32 v25, s52, v25
    v_cvt_pk_bf16_f32 v161, v24, v25
    v_accvgpr_write_b32 a217, v161
    v_lshlrev_b32 v24, 16, v162
    v_and_b32 v25, 4294901760, v162
    v_mul_f32 v24, s52, v24
    v_mul_f32 v25, s52, v25
    v_cvt_pk_bf16_f32 v162, v24, v25
    v_accvgpr_write_b32 a218, v162
    v_lshlrev_b32 v24, 16, v163
    v_and_b32 v25, 4294901760, v163
    v_mul_f32 v24, s52, v24
    v_mul_f32 v25, s52, v25
    v_cvt_pk_bf16_f32 v163, v24, v25
    v_accvgpr_write_b32 a219, v163
    v_lshlrev_b32 v24, 16, v164
    v_and_b32 v25, 4294901760, v164
    v_mul_f32 v24, s52, v24
    v_mul_f32 v25, s52, v25
    v_cvt_pk_bf16_f32 v164, v24, v25
    v_accvgpr_write_b32 a220, v164
    v_lshlrev_b32 v24, 16, v165
    v_and_b32 v25, 4294901760, v165
    v_mul_f32 v24, s52, v24
    v_mul_f32 v25, s52, v25
    v_cvt_pk_bf16_f32 v165, v24, v25
    v_accvgpr_write_b32 a221, v165
    v_lshlrev_b32 v24, 16, v166
    v_and_b32 v25, 4294901760, v166
    v_mul_f32 v24, s52, v24
    v_mul_f32 v25, s52, v25
    v_cvt_pk_bf16_f32 v166, v24, v25
    v_accvgpr_write_b32 a222, v166
    v_lshlrev_b32 v24, 16, v167
    v_and_b32 v25, 4294901760, v167
    v_mul_f32 v24, s52, v24
    v_mul_f32 v25, s52, v25
    v_cvt_pk_bf16_f32 v167, v24, v25
    v_accvgpr_write_b32 a223, v167
    v_lshlrev_b32 v24, 16, v168
    v_and_b32 v25, 4294901760, v168
    v_mul_f32 v24, s52, v24
    v_mul_f32 v25, s52, v25
    v_cvt_pk_bf16_f32 v168, v24, v25
    v_accvgpr_write_b32 a224, v168
    v_lshlrev_b32 v24, 16, v169
    v_and_b32 v25, 4294901760, v169
    v_mul_f32 v24, s52, v24
    v_mul_f32 v25, s52, v25
    v_cvt_pk_bf16_f32 v169, v24, v25
    v_accvgpr_write_b32 a225, v169
    v_lshlrev_b32 v24, 16, v170
    v_and_b32 v25, 4294901760, v170
    v_mul_f32 v24, s52, v24
    v_mul_f32 v25, s52, v25
    v_cvt_pk_bf16_f32 v170, v24, v25
    v_accvgpr_write_b32 a226, v170
    v_lshlrev_b32 v24, 16, v171
    v_and_b32 v25, 4294901760, v171
    v_mul_f32 v24, s52, v24
    v_mul_f32 v25, s52, v25
    v_cvt_pk_bf16_f32 v171, v24, v25
    v_accvgpr_write_b32 a227, v171
    v_lshlrev_b32 v24, 16, v172
    v_and_b32 v25, 4294901760, v172
    v_mul_f32 v24, s52, v24
    v_mul_f32 v25, s52, v25
    v_cvt_pk_bf16_f32 v172, v24, v25
    v_accvgpr_write_b32 a228, v172
    v_lshlrev_b32 v24, 16, v173
    v_and_b32 v25, 4294901760, v173
    v_mul_f32 v24, s52, v24
    v_mul_f32 v25, s52, v25
    v_cvt_pk_bf16_f32 v173, v24, v25
    v_accvgpr_write_b32 a229, v173
    v_lshlrev_b32 v24, 16, v174
    v_and_b32 v25, 4294901760, v174
    v_mul_f32 v24, s52, v24
    v_mul_f32 v25, s52, v25
    v_cvt_pk_bf16_f32 v174, v24, v25
    v_accvgpr_write_b32 a230, v174
    v_lshlrev_b32 v24, 16, v175
    v_and_b32 v25, 4294901760, v175
    v_mul_f32 v24, s52, v24
    v_mul_f32 v25, s52, v25
    v_cvt_pk_bf16_f32 v175, v24, v25
    v_accvgpr_write_b32 a231, v175
    v_lshlrev_b32 v24, 16, v176
    v_and_b32 v25, 4294901760, v176
    v_mul_f32 v24, s52, v24
    v_mul_f32 v25, s52, v25
    v_cvt_pk_bf16_f32 v176, v24, v25
    v_accvgpr_write_b32 a232, v176
    v_lshlrev_b32 v24, 16, v177
    v_and_b32 v25, 4294901760, v177
    v_mul_f32 v24, s52, v24
    v_mul_f32 v25, s52, v25
    v_cvt_pk_bf16_f32 v177, v24, v25
    v_accvgpr_write_b32 a233, v177
    v_lshlrev_b32 v24, 16, v178
    v_and_b32 v25, 4294901760, v178
    v_mul_f32 v24, s52, v24
    v_mul_f32 v25, s52, v25
    v_cvt_pk_bf16_f32 v178, v24, v25
    v_accvgpr_write_b32 a234, v178
    v_lshlrev_b32 v24, 16, v179
    v_and_b32 v25, 4294901760, v179
    v_mul_f32 v24, s52, v24
    v_mul_f32 v25, s52, v25
    v_cvt_pk_bf16_f32 v179, v24, v25
    v_accvgpr_write_b32 a235, v179
    v_lshlrev_b32 v24, 16, v180
    v_and_b32 v25, 4294901760, v180
    v_mul_f32 v24, s52, v24
    v_mul_f32 v25, s52, v25
    v_cvt_pk_bf16_f32 v180, v24, v25
    v_accvgpr_write_b32 a236, v180
    v_lshlrev_b32 v24, 16, v181
    v_and_b32 v25, 4294901760, v181
    v_mul_f32 v24, s52, v24
    v_mul_f32 v25, s52, v25
    v_cvt_pk_bf16_f32 v181, v24, v25
    v_accvgpr_write_b32 a237, v181
    v_lshlrev_b32 v24, 16, v182
    v_and_b32 v25, 4294901760, v182
    v_mul_f32 v24, s52, v24
    v_mul_f32 v25, s52, v25
    v_cvt_pk_bf16_f32 v182, v24, v25
    v_accvgpr_write_b32 a238, v182
    v_lshlrev_b32 v24, 16, v183
    v_and_b32 v25, 4294901760, v183
    v_mul_f32 v24, s52, v24
    v_mul_f32 v25, s52, v25
    v_cvt_pk_bf16_f32 v183, v24, v25
    v_accvgpr_write_b32 a239, v183
    s_mul_i32 s55, s50, 6144
    s_sub_u32 s56, 6144, s55
    v_add_u32 v27, s56, v26
    v_add_u32 v26, s55, v26
    v_mov_b32 v208, 4286578688
    v_mov_b32 v209, 4286578688
    v_mov_b32 v210, 4286578688
    v_mov_b32 v211, 4286578688
    v_mov_b32 v212, 4286578688
    s_mov_b32 s55, 184320
L_fb_loop:
    buffer_load_dwordx4 v[160:163], v26, s[20:23], s55 offen offset:0
    buffer_load_dwordx4 v[164:167], v26, s[20:23], s55 offen offset:64
    buffer_load_dwordx4 v[168:171], v26, s[20:23], s55 offen offset:128
    buffer_load_dwordx4 v[172:175], v26, s[20:23], s55 offen offset:192
    buffer_load_dwordx4 v[176:179], v26, s[20:23], s55 offen offset:256
    buffer_load_dwordx4 v[180:183], v26, s[20:23], s55 offen offset:320
    buffer_load_dwordx4 v[184:187], v27, s[20:23], s55 offen offset:0
    buffer_load_dwordx4 v[188:191], v27, s[20:23], s55 offen offset:64
    buffer_load_dwordx4 v[192:195], v27, s[20:23], s55 offen offset:128
    buffer_load_dwordx4 v[196:199], v27, s[20:23], s55 offen offset:192
    buffer_load_dwordx4 v[200:203], v27, s[20:23], s55 offen offset:256
    buffer_load_dwordx4 v[204:207], v27, s[20:23], s55 offen offset:320
    s_waitcnt vmcnt(0)
    v_mfma_f32_16x16x32_bf16 v[96:99], v[160:163], a[120:123], 0
    v_mfma_f32_16x16x32_bf16 v[104:107], v[160:163], a[144:147], 0
    v_mfma_f32_16x16x32_bf16 v[112:115], v[160:163], a[168:171], 0
    v_mfma_f32_16x16x32_bf16 v[120:123], v[160:163], a[192:195], 0
    v_mfma_f32_16x16x32_bf16 v[88:91], v[160:163], a[216:219], 0
    v_mfma_f32_16x16x32_bf16 v[96:99], v[164:167], a[124:127], v[96:99]
    v_mfma_f32_16x16x32_bf16 v[104:107], v[164:167], a[148:151], v[104:107]
    v_mfma_f32_16x16x32_bf16 v[112:115], v[164:167], a[172:175], v[112:115]
    v_mfma_f32_16x16x32_bf16 v[120:123], v[164:167], a[196:199], v[120:123]
    v_mfma_f32_16x16x32_bf16 v[88:91], v[164:167], a[220:223], v[88:91]
    v_mfma_f32_16x16x32_bf16 v[96:99], v[168:171], a[128:131], v[96:99]
    v_mfma_f32_16x16x32_bf16 v[104:107], v[168:171], a[152:155], v[104:107]
    v_mfma_f32_16x16x32_bf16 v[112:115], v[168:171], a[176:179], v[112:115]
    v_mfma_f32_16x16x32_bf16 v[120:123], v[168:171], a[200:203], v[120:123]
    v_mfma_f32_16x16x32_bf16 v[88:91], v[168:171], a[224:227], v[88:91]
    v_mfma_f32_16x16x32_bf16 v[96:99], v[172:175], a[132:135], v[96:99]
    v_mfma_f32_16x16x32_bf16 v[104:107], v[172:175], a[156:159], v[104:107]
    v_mfma_f32_16x16x32_bf16 v[112:115], v[172:175], a[180:183], v[112:115]
    v_mfma_f32_16x16x32_bf16 v[120:123], v[172:175], a[204:207], v[120:123]
    v_mfma_f32_16x16x32_bf16 v[88:91], v[172:175], a[228:231], v[88:91]
    v_mfma_f32_16x16x32_bf16 v[96:99], v[176:179], a[136:139], v[96:99]
    v_mfma_f32_16x16x32_bf16 v[104:107], v[176:179], a[160:163], v[104:107]
    v_mfma_f32_16x16x32_bf16 v[112:115], v[176:179], a[184:187], v[112:115]
    v_mfma_f32_16x16x32_bf16 v[120:123], v[176:179], a[208:211], v[120:123]
    v_mfma_f32_16x16x32_bf16 v[88:91], v[176:179], a[232:235], v[88:91]
    v_mfma_f32_16x16x32_bf16 v[96:99], v[180:183], a[140:143], v[96:99]
    v_mfma_f32_16x16x32_bf16 v[104:107], v[180:183], a[164:167], v[104:107]
    v_mfma_f32_16x16x32_bf16 v[112:115], v[180:183], a[188:191], v[112:115]
    v_mfma_f32_16x16x32_bf16 v[120:123], v[180:183], a[212:215], v[120:123]
    v_mfma_f32_16x16x32_bf16 v[88:91], v[180:183], a[236:239], v[88:91]
    v_mfma_f32_16x16x32_bf16 v[100:103], v[184:187], a[120:123], 0
    v_mfma_f32_16x16x32_bf16 v[108:111], v[184:187], a[144:147], 0
    v_mfma_f32_16x16x32_bf16 v[116:119], v[184:187], a[168:171], 0
    v_mfma_f32_16x16x32_bf16 v[124:127], v[184:187], a[192:195], 0
    v_mfma_f32_16x16x32_bf16 v[92:95], v[184:187], a[216:219], 0
    v_mfma_f32_16x16x32_bf16 v[100:103], v[188:191], a[124:127], v[100:103]
    v_mfma_f32_16x16x32_bf16 v[108:111], v[188:191], a[148:151], v[108:111]
    v_mfma_f32_16x16x32_bf16 v[116:119], v[188:191], a[172:175], v[116:119]
    v_mfma_f32_16x16x32_bf16 v[124:127], v[188:191], a[196:199], v[124:127]
    v_mfma_f32_16x16x32_bf16 v[92:95], v[188:191], a[220:223], v[92:95]
    v_mfma_f32_16x16x32_bf16 v[100:103], v[192:195], a[128:131], v[100:103]
    v_mfma_f32_16x16x32_bf16 v[108:111], v[192:195], a[152:155], v[108:111]
    v_mfma_f32_16x16x32_bf16 v[116:119], v[192:195], a[176:179], v[116:119]
    v_mfma_f32_16x16x32_bf16 v[124:127], v[192:195], a[200:203], v[124:127]
    v_mfma_f32_16x16x32_bf16 v[92:95], v[192:195], a[224:227], v[92:95]
    v_mfma_f32_16x16x32_bf16 v[100:103], v[196:199], a[132:135], v[100:103]
    v_mfma_f32_16x16x32_bf16 v[108:111], v[196:199], a[156:159], v[108:111]
    v_mfma_f32_16x16x32_bf16 v[116:119], v[196:199], a[180:183], v[116:119]
    v_mfma_f32_16x16x32_bf16 v[124:127], v[196:199], a[204:207], v[124:127]
    v_mfma_f32_16x16x32_bf16 v[92:95], v[196:199], a[228:231], v[92:95]
    v_mfma_f32_16x16x32_bf16 v[100:103], v[200:203], a[136:139], v[100:103]
    v_mfma_f32_16x16x32_bf16 v[108:111], v[200:203], a[160:163], v[108:111]
    v_mfma_f32_16x16x32_bf16 v[116:119], v[200:203], a[184:187], v[116:119]
    v_mfma_f32_16x16x32_bf16 v[124:127], v[200:203], a[208:211], v[124:127]
    v_mfma_f32_16x16x32_bf16 v[92:95], v[200:203], a[232:235], v[92:95]
    v_mfma_f32_16x16x32_bf16 v[100:103], v[204:207], a[140:143], v[100:103]
    v_mfma_f32_16x16x32_bf16 v[108:111], v[204:207], a[164:167], v[108:111]
    v_mfma_f32_16x16x32_bf16 v[116:119], v[204:207], a[188:191], v[116:119]
    v_mfma_f32_16x16x32_bf16 v[124:127], v[204:207], a[212:215], v[124:127]
    v_mfma_f32_16x16x32_bf16 v[92:95], v[204:207], a[236:239], v[92:95]
    s_nop 15
    v_max3_f32 v208, v208, v96, v97
    v_max3_f32 v208, v208, v98, v99
    v_max3_f32 v208, v208, v100, v101
    v_max3_f32 v208, v208, v102, v103
    v_max3_f32 v209, v209, v104, v105
    v_max3_f32 v209, v209, v106, v107
    v_max3_f32 v209, v209, v108, v109
    v_max3_f32 v209, v209, v110, v111
    v_max3_f32 v210, v210, v112, v113
    v_max3_f32 v210, v210, v114, v115
    v_max3_f32 v210, v210, v116, v117
    v_max3_f32 v210, v210, v118, v119
    v_max3_f32 v211, v211, v120, v121
    v_max3_f32 v211, v211, v122, v123
    v_max3_f32 v211, v211, v124, v125
    v_max3_f32 v211, v211, v126, v127
    v_max3_f32 v212, v212, v88, v89
    v_max3_f32 v212, v212, v90, v91
    v_max3_f32 v212, v212, v92, v93
    v_max3_f32 v212, v212, v94, v95
    s_sub_u32 s55, s55, 12288
    s_cbranch_scc0 L_fb_loop
    v_mov_b32 v28, v208
    s_nop 1
    v_permlane16_swap_b32 v208, v28
    v_max_f32 v208, v208, v28
    v_mov_b32 v28, v208
    s_nop 1
    v_permlane32_swap_b32 v208, v28
    v_max_f32 v208, v208, v28
    v_sub_f32 v68, 0, v208
    v_sub_f32 v69, 0, v208
    v_sub_f32 v70, 0, v208
    v_sub_f32 v71, 0, v208
    v_mov_b32 v28, v209
    s_nop 1
    v_permlane16_swap_b32 v209, v28
    v_max_f32 v209, v209, v28
    v_mov_b32 v28, v209
    s_nop 1
    v_permlane32_swap_b32 v209, v28
    v_max_f32 v209, v209, v28
    v_sub_f32 v72, 0, v209
    v_sub_f32 v73, 0, v209
    v_sub_f32 v74, 0, v209
    v_sub_f32 v75, 0, v209
    v_mov_b32 v28, v210
    s_nop 1
    v_permlane16_swap_b32 v210, v28
    v_max_f32 v210, v210, v28
    v_mov_b32 v28, v210
    s_nop 1
    v_permlane32_swap_b32 v210, v28
    v_max_f32 v210, v210, v28
    v_sub_f32 v76, 0, v210
    v_sub_f32 v77, 0, v210
    v_sub_f32 v78, 0, v210
    v_sub_f32 v79, 0, v210
    v_mov_b32 v28, v211
    s_nop 1
    v_permlane16_swap_b32 v211, v28
    v_max_f32 v211, v211, v28
    v_mov_b32 v28, v211
    s_nop 1
    v_permlane32_swap_b32 v211, v28
    v_max_f32 v211, v211, v28
    v_sub_f32 v80, 0, v211
    v_sub_f32 v81, 0, v211
    v_sub_f32 v82, 0, v211
    v_sub_f32 v83, 0, v211
    v_mov_b32 v28, v212
    s_nop 1
    v_permlane16_swap_b32 v212, v28
    v_max_f32 v212, v212, v28
    v_mov_b32 v28, v212
    s_nop 1
    v_permlane32_swap_b32 v212, v28
    v_max_f32 v212, v212, v28
    v_sub_f32 v84, 0, v212
    v_sub_f32 v85, 0, v212
    v_sub_f32 v86, 0, v212
    v_sub_f32 v87, 0, v212
    v_mfma_f32_16x16x32_bf16 v[96:99], v[160:163], a[120:123], v[68:71]
    v_mfma_f32_16x16x32_bf16 v[104:107], v[160:163], a[144:147], v[72:75]
    v_mfma_f32_16x16x32_bf16 v[112:115], v[160:163], a[168:171], v[76:79]
    v_mfma_f32_16x16x32_bf16 v[120:123], v[160:163], a[192:195], v[80:83]
    v_mfma_f32_16x16x32_bf16 v[88:91], v[160:163], a[216:219], v[84:87]
    v_mfma_f32_16x16x32_bf16 v[96:99], v[164:167], a[124:127], v[96:99]
    v_mfma_f32_16x16x32_bf16 v[104:107], v[164:167], a[148:151], v[104:107]
    v_mfma_f32_16x16x32_bf16 v[112:115], v[164:167], a[172:175], v[112:115]
    v_mfma_f32_16x16x32_bf16 v[120:123], v[164:167], a[196:199], v[120:123]
    v_mfma_f32_16x16x32_bf16 v[88:91], v[164:167], a[220:223], v[88:91]
    v_mfma_f32_16x16x32_bf16 v[96:99], v[168:171], a[128:131], v[96:99]
    v_mfma_f32_16x16x32_bf16 v[104:107], v[168:171], a[152:155], v[104:107]
    v_mfma_f32_16x16x32_bf16 v[112:115], v[168:171], a[176:179], v[112:115]
    v_mfma_f32_16x16x32_bf16 v[120:123], v[168:171], a[200:203], v[120:123]
    v_mfma_f32_16x16x32_bf16 v[88:91], v[168:171], a[224:227], v[88:91]
    v_mfma_f32_16x16x32_bf16 v[96:99], v[172:175], a[132:135], v[96:99]
    v_mfma_f32_16x16x32_bf16 v[104:107], v[172:175], a[156:159], v[104:107]
    v_mfma_f32_16x16x32_bf16 v[112:115], v[172:175], a[180:183], v[112:115]
    v_mfma_f32_16x16x32_bf16 v[120:123], v[172:175], a[204:207], v[120:123]
    v_mfma_f32_16x16x32_bf16 v[88:91], v[172:175], a[228:231], v[88:91]
    v_mfma_f32_16x16x32_bf16 v[96:99], v[176:179], a[136:139], v[96:99]
    v_mfma_f32_16x16x32_bf16 v[104:107], v[176:179], a[160:163], v[104:107]
    v_mfma_f32_16x16x32_bf16 v[112:115], v[176:179], a[184:187], v[112:115]
    v_mfma_f32_16x16x32_bf16 v[120:123], v[176:179], a[208:211], v[120:123]
    v_mfma_f32_16x16x32_bf16 v[88:91], v[176:179], a[232:235], v[88:91]
    v_mfma_f32_16x16x32_bf16 v[96:99], v[180:183], a[140:143], v[96:99]
    v_mfma_f32_16x16x32_bf16 v[104:107], v[180:183], a[164:167], v[104:107]
    v_mfma_f32_16x16x32_bf16 v[112:115], v[180:183], a[188:191], v[112:115]
    v_mfma_f32_16x16x32_bf16 v[120:123], v[180:183], a[212:215], v[120:123]
    v_mfma_f32_16x16x32_bf16 v[88:91], v[180:183], a[236:239], v[88:91]
    v_mfma_f32_16x16x32_bf16 v[100:103], v[184:187], a[120:123], v[68:71]
    v_mfma_f32_16x16x32_bf16 v[108:111], v[184:187], a[144:147], v[72:75]
    v_mfma_f32_16x16x32_bf16 v[116:119], v[184:187], a[168:171], v[76:79]
    v_mfma_f32_16x16x32_bf16 v[124:127], v[184:187], a[192:195], v[80:83]
    v_mfma_f32_16x16x32_bf16 v[92:95], v[184:187], a[216:219], v[84:87]
    v_mfma_f32_16x16x32_bf16 v[100:103], v[188:191], a[124:127], v[100:103]
    v_mfma_f32_16x16x32_bf16 v[108:111], v[188:191], a[148:151], v[108:111]
    v_mfma_f32_16x16x32_bf16 v[116:119], v[188:191], a[172:175], v[116:119]
    v_mfma_f32_16x16x32_bf16 v[124:127], v[188:191], a[196:199], v[124:127]
    v_mfma_f32_16x16x32_bf16 v[92:95], v[188:191], a[220:223], v[92:95]
    v_mfma_f32_16x16x32_bf16 v[100:103], v[192:195], a[128:131], v[100:103]
    v_mfma_f32_16x16x32_bf16 v[108:111], v[192:195], a[152:155], v[108:111]
    v_mfma_f32_16x16x32_bf16 v[116:119], v[192:195], a[176:179], v[116:119]
    v_mfma_f32_16x16x32_bf16 v[124:127], v[192:195], a[200:203], v[124:127]
    v_mfma_f32_16x16x32_bf16 v[92:95], v[192:195], a[224:227], v[92:95]
    v_mfma_f32_16x16x32_bf16 v[100:103], v[196:199], a[132:135], v[100:103]
    v_mfma_f32_16x16x32_bf16 v[108:111], v[196:199], a[156:159], v[108:111]
    v_mfma_f32_16x16x32_bf16 v[116:119], v[196:199], a[180:183], v[116:119]
    v_mfma_f32_16x16x32_bf16 v[124:127], v[196:199], a[204:207], v[124:127]
    v_mfma_f32_16x16x32_bf16 v[92:95], v[196:199], a[228:231], v[92:95]
    v_mfma_f32_16x16x32_bf16 v[100:103], v[200:203], a[136:139], v[100:103]
    v_mfma_f32_16x16x32_bf16 v[108:111], v[200:203], a[160:163], v[108:111]
    v_mfma_f32_16x16x32_bf16 v[116:119], v[200:203], a[184:187], v[116:119]
    v_mfma_f32_16x16x32_bf16 v[124:127], v[200:203], a[208:211], v[124:127]
    v_mfma_f32_16x16x32_bf16 v[92:95], v[200:203], a[232:235], v[92:95]
    v_mfma_f32_16x16x32_bf16 v[100:103], v[204:207], a[140:143], v[100:103]
    v_mfma_f32_16x16x32_bf16 v[108:111], v[204:207], a[164:167], v[108:111]
    v_mfma_f32_16x16x32_bf16 v[116:119], v[204:207], a[188:191], v[116:119]
    v_mfma_f32_16x16x32_bf16 v[124:127], v[204:207], a[212:215], v[124:127]
    v_mfma_f32_16x16x32_bf16 v[92:95], v[204:207], a[236:239], v[92:95]
    v_mov_b32 v128, 0
    v_mov_b32 v129, 0
    v_mov_b32 v130, 0
    v_mov_b32 v131, 0
    v_mov_b32 v17, 0
    v_mov_b32 v18, 0
    v_mov_b32 v19, 0
    v_mov_b32 v20, 0
    v_mov_b32 v21, 0
    v_mfma_f32_32x32x16_bf16 a[0:15], v[128:131], v[128:131], 0
    v_mfma_f32_32x32x16_bf16 a[16:31], v[128:131], v[128:131], 0
    v_mfma_f32_32x32x16_bf16 a[32:47], v[128:131], v[128:131], 0
    v_mfma_f32_32x32x16_bf16 a[48:63], v[128:131], v[128:131], 0
    v_mfma_f32_32x32x16_bf16 a[64:79], v[128:131], v[128:131], 0
    v_mfma_f32_32x32x16_bf16 a[80:95], v[128:131], v[128:131], 0
    v_mfma_f32_32x32x16_bf16 a[96:111], v[128:131], v[128:131], 0
    v_mfma_f32_16x16x32_bf16 a[112:115], v[128:131], v[128:131], 0
    v_mfma_f32_16x16x32_bf16 a[116:119], v[128:131], v[128:131], 0
    v_mfma_f32_32x32x16_bf16 v[160:175], v[128:131], v[128:131], 0
    v_mfma_f32_32x32x16_bf16 v[176:191], v[128:131], v[128:131], 0
    v_mfma_f32_32x32x16_bf16 v[192:207], v[128:131], v[128:131], 0
    v_mfma_f32_32x32x16_bf16 v[208:223], v[128:131], v[128:131], 0
    v_mfma_f32_32x32x16_bf16 v[224:239], v[128:131], v[128:131], 0
    v_mfma_f32_32x32x16_bf16 v[240:255], v[128:131], v[128:131], 0
    v_exp_f32 v88, v88
    v_exp_f32 v89, v89
    v_add_f32 v21, v21, v88
    v_add_f32 v21, v21, v89
    v_cvt_pk_bf16_f32 v88, v88, v89
    v_exp_f32 v90, v90
    v_exp_f32 v91, v91
    v_add_f32 v21, v21, v90
    v_add_f32 v21, v21, v91
    v_cvt_pk_bf16_f32 v89, v90, v91
    v_exp_f32 v92, v92
    v_exp_f32 v93, v93
    s_nop 0
    v_cvt_pk_bf16_f32 v92, v92, v93
    v_exp_f32 v94, v94
    v_exp_f32 v95, v95
    s_nop 0
    v_cvt_pk_bf16_f32 v93, v94, v95
    ds_write_b64 v23, v[92:93] offset:0
    v_exp_f32 v96, v96
    v_exp_f32 v97, v97
    v_add_f32 v17, v17, v96
    v_add_f32 v17, v17, v97
    v_cvt_pk_bf16_f32 v96, v96, v97
    v_exp_f32 v98, v98
    v_exp_f32 v99, v99
    v_add_f32 v17, v17, v98
    v_add_f32 v17, v17, v99
    v_cvt_pk_bf16_f32 v97, v98, v99
    v_exp_f32 v100, v100
    v_exp_f32 v101, v101
    v_add_f32 v17, v17, v100
    v_add_f32 v17, v17, v101
    v_cvt_pk_bf16_f32 v98, v100, v101
    v_exp_f32 v102, v102
    v_exp_f32 v103, v103
    v_add_f32 v17, v17, v102
    v_add_f32 v17, v17, v103
    v_cvt_pk_bf16_f32 v99, v102, v103
    v_exp_f32 v104, v104
    v_exp_f32 v105, v105
    v_add_f32 v18, v18, v104
    v_add_f32 v18, v18, v105
    v_cvt_pk_bf16_f32 v104, v104, v105
    v_exp_f32 v106, v106
    v_exp_f32 v107, v107
    v_add_f32 v18, v18, v106
    v_add_f32 v18, v18, v107
    v_cvt_pk_bf16_f32 v105, v106, v107
    v_exp_f32 v108, v108
    v_exp_f32 v109, v109
    v_add_f32 v18, v18, v108
    v_add_f32 v18, v18, v109
    v_cvt_pk_bf16_f32 v106, v108, v109
    v_mov_b32 v1, v7
    v_mov_b32 v2, v8
    s_mov_b32 s46, 36864
    s_mov_b32 s36, 0
    s_mov_b32 s37, 49152
    s_mov_b32 s38, 98304
    s_waitcnt vmcnt(0) lgkmcnt(0)
    s_barrier
    ds_read_b128 v[44:47], v1 offset:24576
    ds_read_b128 v[48:51], v1 offset:25088
    ds_read_b128 v[52:55], v1 offset:25600
    ds_read_b128 v[56:59], v1 offset:26112
    ds_read_b128 v[60:63], v1 offset:26624
    s_nop 7
    s_branch L_loop
.section .rodata,"a"
.p2align 6
.amdhsa_kernel standalone__gqa_softmax__near_ridge_kernel
  .amdhsa_next_free_vgpr 512
  .amdhsa_next_free_sgpr 102
  .amdhsa_accum_offset 256
  .amdhsa_group_segment_fixed_size 0
  .amdhsa_kernarg_size 48
  .amdhsa_user_sgpr_count 2
  .amdhsa_user_sgpr_kernarg_segment_ptr 1
  .amdhsa_system_sgpr_workgroup_id_x 1
  .amdhsa_float_denorm_mode_32 3
.end_amdhsa_kernel
```
